```python
import torch

def _softmax(x, axis=-1):
    return torch.softmax(x, dim=axis)
def _gelu(x):
    return torch.nn.functional.gelu(x, approximate="tanh")
def _silu(x):
    return torch.nn.functional.silu(x)
def _sigmoid(x):
    return torch.sigmoid(x)
def _layernorm(x, axis=-1, eps=1e-5):
    m = x.mean(dim=axis, keepdim=True)
    v = x.var(dim=axis, keepdim=True, unbiased=False)
    return (x - m) / torch.sqrt(v + eps)
def _scatter_add(tgt, idx, src, axis=0):
    return tgt.clone().index_add_(axis, idx, src)
def _segment_sum(src, seg, n):
    out = torch.zeros((n,) + src.shape[1:], dtype=src.dtype)
    return out.index_add_(0, seg, src)
def _pad(x, pw):
    flat = tuple(v for pair in reversed(pw) for v in pair)
    return torch.nn.functional.pad(x, flat)

kernel_name = 'gated_mix__ssm_conv_s4d__linear_attn_block__prompt'

def setup_inputs():

    _w = (lambda a: (lambda t: t.to(torch.bfloat16) if t.is_floating_point() else t)(torch.as_tensor(a)))
    def _A_setup():
        Bsz, L, D, N = 1, 2048, 1024, 128
        return {
            "u": _w((lambda *s: torch.randn(*s, dtype=torch.bfloat16) * 0.05)(Bsz, L, D)),
            "log_A_real": _w((lambda *s: torch.randn(*s, dtype=torch.bfloat16) * 3.2)(D, N) * 0.5),
            "A_imag": _w((lambda *s: torch.randn(*s, dtype=torch.bfloat16) * 0.05)(D, N) * 3.14),
            "C_real": _w((lambda *s: torch.randn(*s, dtype=torch.bfloat16) * 0.8)(D, N) / N ** 0.5),
            "C_imag": _w((lambda *s: torch.randn(*s, dtype=torch.bfloat16) * 0.8)(D, N) / N ** 0.5),
            "log_dt": _w((lambda *s: torch.randn(*s, dtype=torch.bfloat16) * 0.05)(D) * 0.5 - 4.0),
            "D_skip": _w((lambda *s: torch.randn(*s, dtype=torch.bfloat16) * 0.1)(D)),
        }
    _A_in = _A_setup()

    def _B_setup():
        B, S, D = 1, 2048, 1024
        return {
            "x": _w((lambda *s: torch.randn(*s, dtype=torch.bfloat16) * 0.05)(B, S, D)),
            "wqkv": _w((lambda *s: torch.randn(*s, dtype=torch.bfloat16) * 0.8)(D, 3 * D)),
            "wo": _w((lambda *s: torch.randn(*s, dtype=torch.bfloat16) * 0.05)(D, D)),
        }
    _B_in = _B_setup()

    return {
        "A_u": _A_in["u"],
        "A_log_A_real": _A_in["log_A_real"],
        "A_A_imag": _A_in["A_imag"],
        "A_C_real": _A_in["C_real"],
        "A_C_imag": _A_in["C_imag"],
        "A_log_dt": _A_in["log_dt"],
        "A_D_skip": _A_in["D_skip"],
        "B_x": _B_in["x"],
        "B_wqkv": _B_in["wqkv"],
        "B_wo": _B_in["wo"],
        "gate_w": _w((lambda *s: torch.randn(*s, dtype=torch.bfloat16) * 0.05)(1024) * 16.0),
    }

def reference(A_u, A_log_A_real, A_A_imag, A_C_real, A_C_imag, A_log_dt, A_D_skip, B_x, B_wqkv, B_wo, gate_w):
    def _A_ref(u, log_A_real, A_imag, C_real, C_imag, log_dt, D_skip):
        L = u.shape[1]
        dt = torch.exp(log_dt)
        A = -torch.exp(log_A_real) + 1j * A_imag
        C = (C_real + 1j * C_imag) * dt[:, None]
        pos = (lambda x, dt: x.to(dt))(torch.arange(L), log_dt.dtype)
        P = torch.exp((A * dt[:, None])[:, :, None] * pos[None, None, :])
        K = 2.0 * torch.einsum("dn,dnl->dl", C, P).real
        L2 = 2 * L
        u_t = (lambda x, *d: x.permute(*d))(u, 0, 2, 1)
        Kf = (lambda x, *a, **k: torch.fft.rfft(x.float(), *a, **k))(K, L2)
        Uf = (lambda x, *a, **k: torch.fft.rfft(x.float(), *a, **k))(u_t, L2)
        y = (lambda x, *a, **k: torch.fft.irfft(x, *a, **k).to(torch.bfloat16))(Uf * Kf[None, :, :], L2)[:, :, :L]
        y = (lambda x, *d: x.permute(*d))(y, 0, 2, 1)
        return y + u * D_skip[None, None, :]

    def _B_ref(x, wqkv, wo):
        B, S, D = x.shape
        H = 32; Dh = D // H
        qkv = (lambda x, *d: x.permute(*d))((x @ wqkv).reshape(B, S, 3, H, Dh), 2, 0, 3, 1, 4)
        q, k, v = qkv[0], qkv[1], qkv[2]
        phi = lambda t: torch.where(t > 0, t + 1, torch.exp(t)) + 1e-6
        pq, pk = phi(q), phi(k)
        kv = torch.einsum("bhsd,bhse->bhde", pk, v)
        z = torch.einsum("bhsd->bhd", pk)
        num = torch.einsum("bhqd,bhde->bhqe", pq, kv)
        den = torch.einsum("bhqd,bhd->bhq", pq, z)[..., None] + 1e-6
        o = num / den
        return (lambda x, *d: x.permute(*d))(o, 0, 2, 1, 3).reshape(B, S, D) @ wo

    x = A_u
    g = _sigmoid((x * gate_w).sum(-1, keepdims=True))
    a = _A_ref(x, A_log_A_real, A_A_imag, A_C_real, A_C_imag, A_log_dt, A_D_skip)
    b = _B_ref(x, B_wqkv, B_wo)
    return g * a + (1 - g) * b
```

```asm
; @launch grid=(256,1,1) block=(512,1,1) lds=163840
.amdgcn_target "amdgcn-amd-amdhsa--gfx950"
.text
.p2align 12
.globl gated_mix__ssm_conv_s4d__linear_attn_block__prompt_kernel
.p2align 8
.type gated_mix__ssm_conv_s4d__linear_attn_block__prompt_kernel,@function
gated_mix__ssm_conv_s4d__linear_attn_block__prompt_kernel:
    s_load_dwordx8 s[56:63], s[0:1], 8
    s_load_dwordx4 s[64:67], s[0:1], 40
    s_load_dwordx2 s[4:5], s[0:1], 0
    s_load_dwordx4 s[8:11], s[0:1], 64
    s_load_dwordx4 s[12:15], s[0:1], 96
    s_load_dwordx2 s[6:7], s[0:1], 80
    s_load_dwordx2 s[68:69], s[0:1], 88
    s_cmp_ge_u32 s2, 256
    s_cbranch_scc1 L_end
    s_and_b32 s3, s2, 7
    s_lshr_b32 s19, s2, 3
    s_and_b32 s20, s3, 1
    s_mul_i32 s20, s20, 8
    s_and_b32 s18, s19, 7
    s_add_u32 s20, s20, s18
    s_lshr_b32 s21, s3, 1
    s_lshl_b32 s21, s21, 2
    s_lshr_b32 s21, 0xc480, s21
    s_and_b32 s21, s21, 12
    s_lshr_b32 s18, s19, 3
    s_add_u32 s21, s21, s18
    s_lshl_b32 s23, s21, 4
    s_add_u32 s23, s23, s20
    v_lshrrev_b32 v1, 6, v0
    v_and_b32 v2, 63, v0
    v_readfirstlane_b32 s22, v1
    s_and_b32 s51, s20, 12
    s_and_b32 s45, s21, 12
    s_add_u32 s51, s51, s45
    s_add_u32 s51, s51, 1
    s_add_u32 s55, s21, 1
    s_and_b32 s55, s55, 3
    s_add_u32 s53, s55, s51
    s_and_b32 s53, s53, 15
    s_cmp_eq_u32 s55, 0
    s_cselect_b32 s47, 1, 0
    s_add_u32 s55, s55, s47
    s_sub_u32 s44, s51, s47
    s_and_b32 s44, s44, 15
    s_and_b32 s40, s22, 3
    s_mov_b32 s26, 4194304
    s_mov_b32 s27, 0x00020000
    s_mov_b32 s30, 6291456
    s_mov_b32 s31, 0x00020000
    s_mov_b32 s34, 33554432
    s_mov_b32 s35, 0x00020000
    s_mov_b32 s38, 2097152
    s_mov_b32 s39, 0x00020000
    s_lshl_b32 s48, s23, 2
    s_add_u32 s47, s40, s48
    s_lshl_b32 s48, s47, 8
    v_lshl_add_u32 v8, v2, 2, s48
    s_lshl_b32 s48, s47, 1
    v_mov_b32 v9, s48
    s_cmp_ge_u32 s22, 4
    s_cbranch_scc1 L_h0
    s_lshl_b32 s45, s19, 5
    v_and_b32 v4, 31, v2
    v_add_u32 v4, s45, v4
    v_mul_u32_u24 v4, 6144, v4
    s_or_b32 s45, s21, 3
    s_lshl_b32 s45, s45, 7
    s_lshl_b32 s46, s22, 11
    s_add_u32 s48, s45, s46
    s_and_b32 s45, s21, 4
    s_cselect_b32 s48, 117440512, s48
    s_lshl_b32 s49, s2, 13
    s_cmp_eq_u32 s22, 3
    s_cselect_b32 s48, 117440512, s48
    s_cselect_b32 s49, s49, 117440512
    v_lshlrev_b32 v5, 7, v2
    s_mov_b32 s70, 16
    s_branch L_h1
L_h0:
    s_add_u32 s45, s51, s40
    s_and_b32 s45, s45, 15
    s_and_b32 s46, s21, 3
    s_lshl_b32 s47, s20, 2
    s_add_u32 s46, s46, s47
    s_lshl_b32 s46, s46, 16
    s_lshl_b32 s47, s45, 7
    s_add_u32 s48, s46, s47
    s_lshl_b32 s45, s45, 2
    s_and_b32 s46, s20, 3
    s_add_u32 s45, s45, s46
    s_mul_i32 s45, s45, 98304
    s_lshl_b32 s46, s21, 7
    s_add_u32 s49, s45, s46
    v_lshlrev_b32 v5, 11, v2
    v_lshrrev_b32 v3, 5, v2
    v_lshl_add_u32 v4, v3, 28, v5
    v_add_u32 v3, 16, v2
    v_lshrrev_b32 v3, 6, v3
    v_lshl_add_u32 v5, v3, 28, v5
    s_mov_b32 s70, 0
L_h1:
    s_waitcnt lgkmcnt(0)
    global_load_dword v32, v8, s[56:57]
    global_load_dword v33, v8, s[58:59]
    global_load_dword v34, v8, s[60:61]
    global_load_dword v35, v8, s[62:63]
    global_load_ushort v30, v9, s[64:65]
    global_load_ushort v31, v9, s[66:67]
    s_mov_b64 s[24:25], s[4:5]
    s_mov_b64 s[28:29], s[8:9]
    s_mov_b64 s[32:33], s[14:15]
    s_mov_b64 s[36:37], s[10:11]
    s_lshr_b32 s96, s3, 1
    s_lshl_b32 s96, s96, 2
    s_and_b32 s18, s19, 3
    s_add_u32 s96, s96, s18
    s_and_b32 s97, s3, 1
    s_lshl_b32 s97, s97, 3
    s_lshr_b32 s18, s19, 2
    s_add_u32 s97, s97, s18
    s_lshl_b32 s98, s96, 1
    s_add_u32 s98, s98, s97
    s_and_b32 s98, s98, 7
    s_cmp_ge_u32 s22, 4
    s_barrier
    s_cbranch_scc1 L_h2
    buffer_load_dword v255, v4, s[28:31], s48 offen
    buffer_load_dword v255, v5, s[36:39], s49 offen
    s_mov_b32 s45, 17997824
    s_load_dword s16, s[14:15], s45
    v_lshlrev_b32 v3, 2, v2
    v_mov_b32 v4, 0
    v_add_u32 v3, 163584, v3
    ds_write_b32 v3, v4
    s_mul_i32 s45, s19, 43
    s_lshr_b32 s45, s45, 8
    s_mul_i32 s45, s45, 6
    s_sub_u32 s45, s19, s45
    s_lshl_b32 s45, s45, 2
    s_add_u32 s45, s45, s22
    s_mov_b64 exec, 0
    s_cmp_ge_u32 s45, 12
    s_cbranch_scc1 L_tr1
    s_cmp_ge_u32 s45, 6
    s_cbranch_scc1 L_tr2
    s_cmp_ge_u32 s45, 3
    s_cbranch_scc1 L_tr3
    s_cmp_ge_u32 s45, 1
    s_cbranch_scc1 L_tr4
    s_branch L_hop0
L_tr4:
    s_cmp_eq_u32 s45, 1
    s_cbranch_scc1 L_hop1
    s_branch L_hop2
L_tr3:
    s_cmp_ge_u32 s45, 4
    s_cbranch_scc1 L_tr5
    s_branch L_hop3
L_tr5:
    s_cmp_eq_u32 s45, 4
    s_cbranch_scc1 L_hop4
    s_branch L_hop5
L_tr2:
    s_cmp_ge_u32 s45, 9
    s_cbranch_scc1 L_tr6
    s_cmp_ge_u32 s45, 7
    s_cbranch_scc1 L_tr7
    s_branch L_hop6
L_tr7:
    s_cmp_eq_u32 s45, 7
    s_cbranch_scc1 L_hop7
    s_branch L_hop8
L_tr6:
    s_cmp_ge_u32 s45, 10
    s_cbranch_scc1 L_tr8
    s_branch L_hop9
L_tr8:
    s_cmp_eq_u32 s45, 10
    s_cbranch_scc1 L_hop10
    s_branch L_hop11
L_tr1:
    s_cmp_ge_u32 s45, 18
    s_cbranch_scc1 L_tr9
    s_cmp_ge_u32 s45, 15
    s_cbranch_scc1 L_tr10
    s_cmp_ge_u32 s45, 13
    s_cbranch_scc1 L_tr11
    s_branch L_hop12
L_tr11:
    s_cmp_eq_u32 s45, 13
    s_cbranch_scc1 L_hop13
    s_branch L_hop14
L_tr10:
    s_cmp_ge_u32 s45, 16
    s_cbranch_scc1 L_tr12
    s_branch L_hop15
L_tr12:
    s_cmp_eq_u32 s45, 16
    s_cbranch_scc1 L_hop16
    s_branch L_hop17
L_tr9:
    s_cmp_ge_u32 s45, 21
    s_cbranch_scc1 L_tr13
    s_cmp_ge_u32 s45, 19
    s_cbranch_scc1 L_tr14
    s_branch L_hop18
L_tr14:
    s_cmp_eq_u32 s45, 19
    s_cbranch_scc1 L_hop19
    s_branch L_hop20
L_tr13:
    s_cmp_ge_u32 s45, 22
    s_cbranch_scc1 L_tr15
    s_branch L_hop21
L_tr15:
    s_cmp_eq_u32 s45, 22
    s_cbranch_scc1 L_hop22
    s_branch L_hop23
L_hop23:
L_hopback:
    s_mov_b64 exec, -1
    v_mov_b64 v[10:11], 0
    v_mov_b64 v[12:13], 0
    v_mov_b64 v[14:15], 0
    v_mov_b64 v[16:17], 0
    v_mov_b64 v[18:19], 0
    v_mov_b64 v[24:25], 0
    v_mov_b64 v[26:27], 0
    v_mov_b64 v[252:253], 0
    s_branch L_kg
L_h2:
    buffer_load_dword v255, v4, s[24:27], s48 offen
    buffer_load_dword v255, v5, s[28:31], s49 offen
    s_and_b32 s47, s22, 1
    v_lshrrev_b32 v3, 3, v2
    v_and_b32 v4, 7, v2
    v_lshrrev_b32 v5, 4, v2
    s_lshl_b32 s41, s20, 7
    s_lshl_b32 s42, s47, 6
    s_add_u32 s41, s41, s42
    v_add_u32 v8, s41, v3
    v_lshlrev_b32 v8, 11, v8
    v_xor_b32 v6, v4, v5
    v_lshl_add_u32 v10, v6, 4, v8
    v_add_u32 v5, 4, v5
    v_xor_b32 v7, v4, v5
    v_lshl_add_u32 v7, v7, 4, v8
    v_add_u32 v11, 16384, v7
    v_add_u32 v12, 32768, v10
    v_add_u32 v13, 49152, v7
    s_lshl_b32 s42, s47, 5
    v_add_u32 v8, s42, v3
    v_mul_u32_u24 v8, 6144, v8
    s_lshl_b32 s42, s21, 7
    v_add_u32 v8, s42, v8
    v_bfe_u32 v5, v3, 1, 1
    v_lshlrev_b32 v5, 1, v5
    v_xor_b32 v6, v4, v5
    v_xor_b32 v7, 4, v6
    v_lshl_add_u32 v14, v6, 4, v8
    v_lshl_add_u32 v7, v7, 4, v8
    v_add_u32 v15, 49152, v7
    v_add_u32 v16, 2048, v14
    v_add_u32 v17, 2048, v15
    v_add_u32 v18, 4096, v14
    v_add_u32 v19, 4096, v15
    s_lshl_b32 s41, s47, 13
    s_lshl_b32 s42, s47, 12
    s_add_u32 s42, s42, 16384
    v_and_b32 v3, 31, v2
    v_mov_b32 v28, v3
    v_cmp_le_u32 vcc, 11, v3
    s_nop 1
    v_subbrev_co_u32 v28, vcc, 0, v28, vcc
    v_cmp_le_u32 vcc, 12, v3
    s_nop 1
    v_subbrev_co_u32 v28, vcc, 0, v28, vcc
    v_cmp_le_u32 vcc, 15, v3
    s_nop 1
    v_subbrev_co_u32 v28, vcc, 0, v28, vcc
    v_cmp_le_u32 vcc, 19, v3
    s_nop 1
    v_subbrev_co_u32 v28, vcc, 0, v28, vcc
    v_cmp_le_u32 vcc, 23, v3
    s_nop 1
    v_subbrev_co_u32 v28, vcc, 0, v28, vcc
    v_mul_u32_u24 v28, 272, v28
    v_mul_u32_u24 v29, 272, v3
    v_lshrrev_b32 v4, 5, v2
L_hop0:
    s_cbranch_execz L_hopback
    v_lshlrev_b32 v4, 4, v4
    s_mul_i32 s47, s40, 7344
    v_add3_u32 v28, v28, v4, s47
    s_mul_i32 s47, s40, 8688
    s_add_u32 s47, s47, 61568
    v_add3_u32 v29, v29, v4, s47
    v_and_b32 v3, 31, v2
    v_lshrrev_b32 v7, 5, v2
    s_mul_i32 s50, s40, 4160
    v_lshl_add_u32 v5, v3, 4, s50
    v_lshl_add_u32 v240, v7, 3, v5
    v_lshl_add_u32 v241, v7, 9, v5
    v_lshl_add_u32 v242, v7, 10, v5
    v_and_b32 v5, 7, v2
    v_lshl_add_u32 v243, v5, 2, s50
    v_lshrrev_b32 v3, 4, v2
    v_bfe_u32 v4, v2, 2, 2
    v_and_b32 v5, 3, v2
    v_sub_u32 v6, v5, v4
    v_lshlrev_b32 v6, 3, v6
    v_lshlrev_b32 v7, 6, v3
    v_sub_u32 v6, v6, v7
    s_add_u32 s47, s50, 224
    v_add_u32 v244, s47, v6
    v_lshl_add_u32 v3, v3, 1, v4
    v_xor_b32 v4, s40, v5
    v_lshlrev_b32 v4, 4, v4
    v_lshl_add_u32 v4, v5, 8, v4
    v_add_u32 v4, 16640, v4
    v_add_u32 v5, 1, v3
    v_lshrrev_b32 v7, 3, v5
    v_lshl_add_u32 v245, v7, 10, v4
    v_bfe_u32 v7, v5, 1, 2
    v_lshl_add_u32 v245, v7, 6, v245
    v_and_b32 v7, 1, v5
    v_lshl_add_u32 v245, v7, 3, v245
    v_add_u32 v5, 2, v3
    v_lshrrev_b32 v7, 3, v5
    v_lshl_add_u32 v246, v7, 10, v4
    v_bfe_u32 v7, v5, 1, 2
    v_lshl_add_u32 v246, v7, 6, v246
    v_and_b32 v7, 1, v5
    v_lshl_add_u32 v246, v7, 3, v246
    v_add_u32 v5, 5, v3
    v_lshrrev_b32 v7, 3, v5
    v_lshl_add_u32 v247, v7, 10, v4
    v_bfe_u32 v7, v5, 1, 2
    v_lshl_add_u32 v247, v7, 6, v247
    v_and_b32 v7, 1, v5
    v_lshl_add_u32 v247, v7, 3, v247
    v_add_u32 v5, 6, v3
    v_lshrrev_b32 v7, 3, v5
    v_lshl_add_u32 v248, v7, 10, v4
    v_bfe_u32 v7, v5, 1, 2
    v_lshl_add_u32 v248, v7, 6, v248
    v_and_b32 v7, 1, v5
    v_lshl_add_u32 v248, v7, 3, v248
    v_lshlrev_b32 v24, 4, v2
    v_lshlrev_b32 v25, 26, v2
    s_and_b32 s58, s22, 1
    s_add_u32 s48, s55, 1
    s_cmp_ge_u32 s48, 3
    s_cselect_b32 s47, 3, 0
    s_sub_u32 s48, s48, s47
    s_mul_i32 s48, s48, 40960
    s_add_u32 s48, s48, 34816
    v_lshrrev_b32 v3, 4, v2
    v_bfe_u32 v4, v2, 2, 2
    v_lshlrev_b32 v5, 12, v3
    v_lshl_add_u32 v5, v4, 9, v5
    v_and_b32 v6, 1, v2
    v_lshl_add_u32 v5, v6, 3, v5
    v_add_u32 v5, s48, v5
    v_bfe_u32 v6, v2, 1, 1
    s_lshl_b32 s47, s58, 2
    v_add_u32 v6, s47, v6
    v_lshlrev_b32 v7, 1, v4
    v_xor_b32 v8, v6, v7
    v_lshl_add_u32 v20, v8, 4, v5
    v_add_u32 v7, 1, v7
    v_xor_b32 v8, v6, v7
    v_lshl_add_u32 v21, v8, 4, v5
    v_xor_b32 v22, 32, v20
    v_xor_b32 v23, 32, v21
    v_lshlrev_b32 v4, 14, v4
    v_lshl_add_u32 v4, v3, 6, v4
    v_and_b32 v5, 3, v2
    v_lshl_add_u32 v26, v5, 4, v4
    s_lshl_b32 s47, s53, 1
    s_add_u32 s47, s47, s58
    s_lshl_b32 s59, s47, 17
    s_lshl_b32 s48, s20, 10
    s_add_u32 s59, s59, s48
    s_add_u32 s59, s59, 0
    s_lshl_b32 s60, s47, 4
    s_add_u32 s60, s60, s20
    s_lshl_b32 s60, s60, 7
    s_add_u32 s60, s60, 18087936
    s_lshl_b32 s61, s21, 1
    s_lshr_b32 s48, s20, 3
    s_add_u32 s61, s61, s48
    s_lshl_b32 s61, s61, 11
    s_add_u32 s61, s61, 18087936
    s_lshl_b32 s62, s23, 14
    s_lshl_b32 s48, s58, 13
    s_add_u32 s62, s62, s48
    s_add_u32 s62, s62, 0
    v_xor_b32 v9, v3, v2
    v_lshlrev_b32 v9, 4, v9
    s_lshl_b32 s47, s21, 1
    s_add_u32 s47, s47, s58
    s_lshl_b32 s48, s47, 9
    v_lshl_add_u32 v250, v2, 3, s48
    s_lshl_b32 s47, s47, 2
    v_add_u32 v4, s47, v3
    v_bfe_u32 v4, v4, 1, 3
    v_bfe_u32 v5, v2, 1, 3
    v_xor_b32 v4, v4, v5
    v_lshlrev_b32 v4, 4, v4
    v_and_b32 v5, 1, v2
    v_lshl_add_u32 v4, v5, 3, v4
    v_add_u32 v251, 157696, v4
    v_mov_b32 v76, 0
    s_lshl_b32 s47, s98, 1
    s_lshl_b32 s47, s47, 17
    s_lshl_b32 s48, s97, 7
    s_add_u32 s64, s47, s48
    s_lshl_b32 s48, s58, 15
    s_add_u32 s64, s64, s48
    v_lshrrev_b32 v4, 4, v2
    v_lshlrev_b32 v5, 11, v2
    v_lshl_add_u32 v252, v4, 28, v5
    s_mov_b32 s56, 75776
L_kg:
    s_mul_i32 s45, s22, 8688
    s_add_u32 m0, s45, 4480
    v_mov_b32 v56, 0x3c00
    s_cmp_ge_u32 s22, 4
    ds_write_addtid_b32 v56 offset:57088
    s_cselect_b64 vcc, -1, 0
    s_waitcnt vmcnt(2)
    v_lshlrev_b32 v30, 16, v30
    v_lshlrev_b32 v36, s70, v32
    v_mul_f32 v30, 1069066811, v30
    v_and_b32 v36, 0xffff0000, v36
    v_exp_f32 v30, v30
    v_mul_f32 v36, 1069066811, v36
    v_lshlrev_b32 v37, s70, v33
    v_exp_f32 v36, v36
    v_cvt_pk_bf16_f32 v30, v30, v30
    v_and_b32 v37, 0xffff0000, v37
    v_and_b32 v30, 0xffff0000, v30
    v_cvt_pk_bf16_f32 v36, v36, v36
    v_mul_f32 v37, v30, v37
    v_and_b32 v36, 0xffff0000, v36
    v_mul_f32 v37, 1042479491, v37
    v_mul_f32 v36, v30, v36
    v_mul_f32 v36, 3216550459, v36
    v_mul_f32 v38, 1090519040, v36
    v_mul_f32 v39, 1090519040, v37
    v_exp_f32 v38, v38
    v_fract_f32 v39, v39
    v_cos_f32 v40, v39
    v_sin_f32 v41, v39
    s_nop 0
    v_pk_mul_f32 v[40:41], v[40:41], v[38:39] op_sel:[0,0] op_sel_hi:[1,0]
    v_pk_mul_f32 v[42:43], v[40:41], v[40:41] op_sel:[0,0] op_sel_hi:[0,1]
    v_cvt_pk_f16_f32 v44, v40, v41
    v_pk_fma_f32 v[42:43], v[40:41], v[40:41], v[42:43] op_sel:[1,1,0] op_sel_hi:[1,0,1] neg_lo:[1,0,0]
    v_pk_mul_f32 v[40:41], v[42:43], v[42:43] op_sel:[0,0] op_sel_hi:[0,1]
    v_cvt_pk_f16_f32 v45, v42, v43
    v_pk_fma_f32 v[40:41], v[42:43], v[42:43], v[40:41] op_sel:[1,1,0] op_sel_hi:[1,0,1] neg_lo:[1,0,0]
    v_pk_mul_f32 v[42:43], v[40:41], v[40:41] op_sel:[0,0] op_sel_hi:[0,1]
    v_cvt_pk_f16_f32 v46, v40, v41
    v_pk_fma_f32 v[42:43], v[40:41], v[40:41], v[42:43] op_sel:[1,1,0] op_sel_hi:[1,0,1] neg_lo:[1,0,0]
    v_pk_mul_f32 v[40:41], v[42:43], v[42:43] op_sel:[0,0] op_sel_hi:[0,1]
    v_cvt_pk_f16_f32 v47, v42, v43
    v_pk_fma_f32 v[40:41], v[42:43], v[42:43], v[40:41] op_sel:[1,1,0] op_sel_hi:[1,0,1] neg_lo:[1,0,0]
L_hop1:
    s_cbranch_execz L_hopback
    v_cvt_pk_f16_f32 v48, v40, v41
    ds_write_addtid_b32 v44 offset:57360
    ds_write_addtid_b32 v45 offset:57632
    ds_write_addtid_b32 v46 offset:58176
    ds_write_addtid_b32 v47 offset:59264
    ds_write_addtid_b32 v48 offset:61440
    v_pk_mul_f16 v56, v44, v45 op_sel:[0,0] op_sel_hi:[0,1]
    v_pk_fma_f16 v56, v44, v45, v56 op_sel:[1,1,0] op_sel_hi:[1,0,1] neg_lo:[1,0,0]
    ds_write_addtid_b32 v56 offset:57904
    v_lshlrev_b32 v3, 16, v34
    v_pk_mul_f16 v57, v44, v46 op_sel:[0,0] op_sel_hi:[0,1]
    v_pk_fma_f16 v57, v44, v46, v57 op_sel:[1,1,0] op_sel_hi:[1,0,1] neg_lo:[1,0,0]
    ds_write_addtid_b32 v57 offset:58448
    v_lshlrev_b32 v4, 16, v35
    v_pk_mul_f16 v58, v45, v46 op_sel:[0,0] op_sel_hi:[0,1]
    v_pk_fma_f16 v58, v45, v46, v58 op_sel:[1,1,0] op_sel_hi:[1,0,1] neg_lo:[1,0,0]
    ds_write_addtid_b32 v58 offset:58720
    v_max3_f32 v3, abs(v3), abs(v4), abs(v34)
    v_pk_mul_f16 v59, v56, v46 op_sel:[0,0] op_sel_hi:[0,1]
    v_pk_fma_f16 v59, v56, v46, v59 op_sel:[1,1,0] op_sel_hi:[1,0,1] neg_lo:[1,0,0]
    ds_write_addtid_b32 v59 offset:58992
    v_max_f32_e64 v3, v3, abs(v35)
    v_pk_mul_f16 v60, v44, v47 op_sel:[0,0] op_sel_hi:[0,1]
    v_pk_fma_f16 v60, v44, v47, v60 op_sel:[1,1,0] op_sel_hi:[1,0,1] neg_lo:[1,0,0]
    ds_write_addtid_b32 v60 offset:59536
    v_max_f32_dpp v3, v3, v3 row_ror:8 row_mask:0xf bank_mask:0xf
    v_pk_mul_f16 v61, v45, v47 op_sel:[0,0] op_sel_hi:[0,1]
    v_pk_fma_f16 v61, v45, v47, v61 op_sel:[1,1,0] op_sel_hi:[1,0,1] neg_lo:[1,0,0]
    ds_write_addtid_b32 v61 offset:59808
    v_max_f32_dpp v3, v3, v3 row_ror:4 row_mask:0xf bank_mask:0xf
    v_pk_mul_f16 v62, v56, v47 op_sel:[0,0] op_sel_hi:[0,1]
    v_pk_fma_f16 v62, v56, v47, v62 op_sel:[1,1,0] op_sel_hi:[1,0,1] neg_lo:[1,0,0]
    ds_write_addtid_b32 v62 offset:60080
    v_max_f32_dpp v3, v3, v3 row_ror:2 row_mask:0xf bank_mask:0xf
    v_pk_mul_f16 v63, v46, v47 op_sel:[0,0] op_sel_hi:[0,1]
    v_pk_fma_f16 v63, v46, v47, v63 op_sel:[1,1,0] op_sel_hi:[1,0,1] neg_lo:[1,0,0]
    ds_write_addtid_b32 v63 offset:60352
    v_max_f32_dpp v3, v3, v3 row_ror:1 row_mask:0xf bank_mask:0xf
    v_pk_mul_f16 v64, v57, v47 op_sel:[0,0] op_sel_hi:[0,1]
    v_pk_fma_f16 v64, v57, v47, v64 op_sel:[1,1,0] op_sel_hi:[1,0,1] neg_lo:[1,0,0]
    ds_write_addtid_b32 v64 offset:60624
    v_readlane_b32 s47, v3, 0
    v_pk_mul_f16 v65, v58, v47 op_sel:[0,0] op_sel_hi:[0,1]
    v_pk_fma_f16 v65, v58, v47, v65 op_sel:[1,1,0] op_sel_hi:[1,0,1] neg_lo:[1,0,0]
    ds_write_addtid_b32 v65 offset:60896
    v_readlane_b32 s48, v3, 16
    v_pk_mul_f16 v66, v59, v47 op_sel:[0,0] op_sel_hi:[0,1]
    v_pk_fma_f16 v66, v59, v47, v66 op_sel:[1,1,0] op_sel_hi:[1,0,1] neg_lo:[1,0,0]
    ds_write_addtid_b32 v66 offset:61168
    v_readlane_b32 s49, v3, 32
    v_pk_mul_f16 v69, v44, v48 op_sel:[0,0] op_sel_hi:[0,1]
    v_pk_fma_f16 v69, v44, v48, v69 op_sel:[1,1,0] op_sel_hi:[1,0,1] neg_lo:[1,0,0]
    ds_write_addtid_b32 v69 offset:61712
    v_readlane_b32 s50, v3, 48
    v_pk_mul_f16 v70, v45, v48 op_sel:[0,0] op_sel_hi:[0,1]
    v_pk_fma_f16 v70, v45, v48, v70 op_sel:[1,1,0] op_sel_hi:[1,0,1] neg_lo:[1,0,0]
    ds_write_addtid_b32 v70 offset:61984
    s_max_u32 s47, s47, s48
    v_pk_mul_f16 v71, v56, v48 op_sel:[0,0] op_sel_hi:[0,1]
    v_pk_fma_f16 v71, v56, v48, v71 op_sel:[1,1,0] op_sel_hi:[1,0,1] neg_lo:[1,0,0]
    ds_write_addtid_b32 v71 offset:62256
    s_max_u32 s49, s49, s50
    v_pk_mul_f16 v68, v46, v48 op_sel:[0,0] op_sel_hi:[0,1]
    v_pk_fma_f16 v68, v46, v48, v68 op_sel:[1,1,0] op_sel_hi:[1,0,1] neg_lo:[1,0,0]
    ds_write_addtid_b32 v68 offset:62528
    s_max_u32 s47, s47, s49
    v_pk_mul_f16 v69, v57, v48 op_sel:[0,0] op_sel_hi:[0,1]
    v_pk_fma_f16 v69, v57, v48, v69 op_sel:[1,1,0] op_sel_hi:[1,0,1] neg_lo:[1,0,0]
    ds_write_addtid_b32 v69 offset:62800
    s_lshr_b32 s47, s47, 23
    v_pk_mul_f16 v70, v58, v48 op_sel:[0,0] op_sel_hi:[0,1]
    v_pk_fma_f16 v70, v58, v48, v70 op_sel:[1,1,0] op_sel_hi:[1,0,1] neg_lo:[1,0,0]
    ds_write_addtid_b32 v70 offset:63072
    s_sub_u32 s47, 264, s47
    v_pk_mul_f16 v71, v59, v48 op_sel:[0,0] op_sel_hi:[0,1]
    v_pk_fma_f16 v71, v59, v48, v71 op_sel:[1,1,0] op_sel_hi:[1,0,1] neg_lo:[1,0,0]
    ds_write_addtid_b32 v71 offset:63344
    s_min_u32 s47, s47, 254
    v_pk_mul_f16 v68, v47, v48 op_sel:[0,0] op_sel_hi:[0,1]
    v_pk_fma_f16 v68, v47, v48, v68 op_sel:[1,1,0] op_sel_hi:[1,0,1] neg_lo:[1,0,0]
    ds_write_addtid_b32 v68 offset:63616
    s_sub_u32 s71, 254, s47
    v_pk_mul_f16 v69, v60, v48 op_sel:[0,0] op_sel_hi:[0,1]
    v_pk_fma_f16 v69, v60, v48, v69 op_sel:[1,1,0] op_sel_hi:[1,0,1] neg_lo:[1,0,0]
    ds_write_addtid_b32 v69 offset:63888
    s_lshl_b32 s47, s47, 23
    v_pk_mul_f16 v70, v61, v48 op_sel:[0,0] op_sel_hi:[0,1]
    v_pk_fma_f16 v70, v61, v48, v70 op_sel:[1,1,0] op_sel_hi:[1,0,1] neg_lo:[1,0,0]
    ds_write_addtid_b32 v70 offset:64160
    s_lshl_b32 s71, s71, 23
    v_pk_mul_f16 v71, v62, v48 op_sel:[0,0] op_sel_hi:[0,1]
    v_pk_fma_f16 v71, v62, v48, v71 op_sel:[1,1,0] op_sel_hi:[1,0,1] neg_lo:[1,0,0]
    ds_write_addtid_b32 v71 offset:64432
    v_pk_mul_f16 v68, v63, v48 op_sel:[0,0] op_sel_hi:[0,1]
    v_pk_fma_f16 v68, v63, v48, v68 op_sel:[1,1,0] op_sel_hi:[1,0,1] neg_lo:[1,0,0]
    ds_write_addtid_b32 v68 offset:64704
    v_pk_mul_f16 v69, v64, v48 op_sel:[0,0] op_sel_hi:[0,1]
    v_pk_fma_f16 v69, v64, v48, v69 op_sel:[1,1,0] op_sel_hi:[1,0,1] neg_lo:[1,0,0]
    ds_write_addtid_b32 v69 offset:64976
    v_pk_mul_f16 v70, v65, v48 op_sel:[0,0] op_sel_hi:[0,1]
    v_pk_fma_f16 v70, v65, v48, v70 op_sel:[1,1,0] op_sel_hi:[1,0,1] neg_lo:[1,0,0]
    ds_write_addtid_b32 v70 offset:65248
    v_pk_mul_f16 v71, v66, v48 op_sel:[0,0] op_sel_hi:[0,1]
    v_pk_fma_f16 v71, v66, v48, v71 op_sel:[1,1,0] op_sel_hi:[1,0,1] neg_lo:[1,0,0]
    ds_write_addtid_b32 v71 offset:65520
    v_lshlrev_b32 v3, s70, v34
    v_lshlrev_b32 v4, s70, v35
    v_and_b32 v3, 0xffff0000, v3
    v_and_b32 v4, 0xffff0000, v4
    v_mul_f32 v3, s47, v3
    v_mul_f32_e64 v4, s47, -v4
    v_cvt_pk_f16_f32 v56, v3, v4
    v_mul_f32 v38, 1065353216, v36
    v_mul_f32 v39, 1065353216, v37
    v_exp_f32 v38, v38
    v_fract_f32 v39, v39
    v_cos_f32 v40, v39
    v_sin_f32 v41, v39
    s_nop 0
    v_pk_mul_f32 v[40:41], v[40:41], v[38:39] op_sel:[0,0] op_sel_hi:[1,0]
    s_mul_i32 m0, s22, 7344
    s_waitcnt lgkmcnt(0)
    s_barrier
    s_cbranch_vccz L_nolo
    ds_read_b128 v[96:99], v29 offset:0
    ds_read_b128 v[100:103], v29 offset:32
    ds_read_b128 v[104:107], v29 offset:64
    ds_read_b128 v[108:111], v29 offset:96
    ds_read_b128 v[112:115], v29 offset:128
    ds_read_b128 v[116:119], v29 offset:160
    ds_read_b128 v[120:123], v29 offset:192
    ds_read_b128 v[124:127], v29 offset:224
    ds_read_b128 v[128:131], v29 offset:34752
    ds_read_b128 v[132:135], v29 offset:34784
    ds_read_b128 v[136:139], v29 offset:34816
    ds_read_b128 v[140:143], v29 offset:34848
    ds_read_b128 v[144:147], v29 offset:34880
    ds_read_b128 v[148:151], v29 offset:34912
L_hop2:
    s_cbranch_execz L_hopback
    ds_read_b128 v[152:155], v29 offset:34944
    ds_read_b128 v[156:159], v29 offset:34976
L_nolo:
    v_pk_mul_f32 v[42:43], v[40:41], v[40:41] op_sel:[0,0] op_sel_hi:[0,1]
    v_cvt_pk_f16_f32 v49, v40, v41
    v_pk_fma_f32 v[42:43], v[40:41], v[40:41], v[42:43] op_sel:[1,1,0] op_sel_hi:[1,0,1] neg_lo:[1,0,0]
    v_pk_mul_f32 v[40:41], v[42:43], v[42:43] op_sel:[0,0] op_sel_hi:[0,1]
    v_cvt_pk_f16_f32 v50, v42, v43
    v_pk_fma_f32 v[40:41], v[42:43], v[42:43], v[40:41] op_sel:[1,1,0] op_sel_hi:[1,0,1] neg_lo:[1,0,0]
    v_cvt_pk_f16_f32 v51, v40, v41
    v_mul_f32 v38, 1132462080, v36
    v_mul_f32 v39, 1132462080, v37
    v_exp_f32 v38, v38
    v_fract_f32 v39, v39
    v_cos_f32 v40, v39
    v_sin_f32 v41, v39
    s_nop 0
    v_pk_mul_f32 v[40:41], v[40:41], v[38:39] op_sel:[0,0] op_sel_hi:[1,0]
    v_pk_mul_f32 v[42:43], v[40:41], v[40:41] op_sel:[0,0] op_sel_hi:[0,1]
    v_cvt_pk_f16_f32 v52, v40, v41
    v_pk_fma_f32 v[42:43], v[40:41], v[40:41], v[42:43] op_sel:[1,1,0] op_sel_hi:[1,0,1] neg_lo:[1,0,0]
    v_pk_mul_f32 v[40:41], v[42:43], v[42:43] op_sel:[0,0] op_sel_hi:[0,1]
    v_cvt_pk_f16_f32 v53, v42, v43
    v_pk_fma_f32 v[40:41], v[42:43], v[42:43], v[40:41] op_sel:[1,1,0] op_sel_hi:[1,0,1] neg_lo:[1,0,0]
    v_cvt_pk_f16_f32 v54, v40, v41
    ds_write_addtid_b32 v56 offset:0
    v_pk_mul_f16 v57, v56, v49 op_sel:[0,0] op_sel_hi:[0,1] neg_hi:[0,1]
    v_pk_fma_f16 v57, v56, v49, v57 op_sel:[1,1,0] op_sel_hi:[1,0,1]
    ds_write_addtid_b32 v57 offset:272
    v_pk_mul_f16 v58, v56, v50 op_sel:[0,0] op_sel_hi:[0,1] neg_hi:[0,1]
    v_pk_fma_f16 v58, v56, v50, v58 op_sel:[1,1,0] op_sel_hi:[1,0,1]
    ds_write_addtid_b32 v58 offset:544
    v_pk_mul_f16 v59, v57, v50 op_sel:[0,0] op_sel_hi:[0,1] neg_hi:[0,1]
    v_pk_fma_f16 v59, v57, v50, v59 op_sel:[1,1,0] op_sel_hi:[1,0,1]
    ds_write_addtid_b32 v59 offset:816
    v_pk_mul_f16 v60, v56, v51 op_sel:[0,0] op_sel_hi:[0,1] neg_hi:[0,1]
    v_pk_fma_f16 v60, v56, v51, v60 op_sel:[1,1,0] op_sel_hi:[1,0,1]
    ds_write_addtid_b32 v60 offset:1088
    v_pk_mul_f16 v72, v57, v51 op_sel:[0,0] op_sel_hi:[0,1] neg_hi:[0,1]
    v_pk_fma_f16 v72, v57, v51, v72 op_sel:[1,1,0] op_sel_hi:[1,0,1]
    ds_write_addtid_b32 v72 offset:1360
    v_pk_mul_f16 v61, v58, v51 op_sel:[0,0] op_sel_hi:[0,1] neg_hi:[0,1]
    v_pk_fma_f16 v61, v58, v51, v61 op_sel:[1,1,0] op_sel_hi:[1,0,1]
    ds_write_addtid_b32 v61 offset:1632
    v_pk_mul_f16 v73, v59, v51 op_sel:[0,0] op_sel_hi:[0,1] neg_hi:[0,1]
    v_pk_fma_f16 v73, v59, v51, v73 op_sel:[1,1,0] op_sel_hi:[1,0,1]
    ds_write_addtid_b32 v73 offset:1904
    v_pk_mul_f16 v62, v56, v44 op_sel:[0,0] op_sel_hi:[0,1] neg_hi:[0,1]
    v_pk_fma_f16 v62, v56, v44, v62 op_sel:[1,1,0] op_sel_hi:[1,0,1]
    v_pk_mul_f16 v63, v56, v52 op_sel:[0,0] op_sel_hi:[0,1] neg_hi:[0,1]
    v_pk_fma_f16 v63, v56, v52, v63 op_sel:[1,1,0] op_sel_hi:[1,0,1]
    ds_write_addtid_b32 v63 offset:2176
    v_pk_mul_f16 v74, v58, v52 op_sel:[0,0] op_sel_hi:[0,1] neg_hi:[0,1]
    v_pk_fma_f16 v74, v58, v52, v74 op_sel:[1,1,0] op_sel_hi:[1,0,1]
    ds_write_addtid_b32 v74 offset:2448
    v_pk_mul_f16 v64, v60, v52 op_sel:[0,0] op_sel_hi:[0,1] neg_hi:[0,1]
    v_pk_fma_f16 v64, v60, v52, v64 op_sel:[1,1,0] op_sel_hi:[1,0,1]
    ds_write_addtid_b32 v64 offset:2720
    v_pk_mul_f16 v75, v61, v52 op_sel:[0,0] op_sel_hi:[0,1] neg_hi:[0,1]
    v_pk_fma_f16 v75, v61, v52, v75 op_sel:[1,1,0] op_sel_hi:[1,0,1]
    ds_write_addtid_b32 v75 offset:2992
    v_pk_mul_f16 v65, v62, v52 op_sel:[0,0] op_sel_hi:[0,1] neg_hi:[0,1]
    v_pk_fma_f16 v65, v62, v52, v65 op_sel:[1,1,0] op_sel_hi:[1,0,1]
    ds_write_addtid_b32 v65 offset:3264
    v_pk_mul_f16 v66, v56, v53 op_sel:[0,0] op_sel_hi:[0,1] neg_hi:[0,1]
    v_pk_fma_f16 v66, v56, v53, v66 op_sel:[1,1,0] op_sel_hi:[1,0,1]
    ds_write_addtid_b32 v66 offset:3536
    v_pk_mul_f16 v72, v60, v53 op_sel:[0,0] op_sel_hi:[0,1] neg_hi:[0,1]
    v_pk_fma_f16 v72, v60, v53, v72 op_sel:[1,1,0] op_sel_hi:[1,0,1]
    ds_write_addtid_b32 v72 offset:3808
    v_pk_mul_f16 v67, v62, v53 op_sel:[0,0] op_sel_hi:[0,1] neg_hi:[0,1]
    v_pk_fma_f16 v67, v62, v53, v67 op_sel:[1,1,0] op_sel_hi:[1,0,1]
    ds_write_addtid_b32 v67 offset:4080
    v_pk_mul_f16 v68, v63, v53 op_sel:[0,0] op_sel_hi:[0,1] neg_hi:[0,1]
    v_pk_fma_f16 v68, v63, v53, v68 op_sel:[1,1,0] op_sel_hi:[1,0,1]
    ds_write_addtid_b32 v68 offset:4352
    v_pk_mul_f16 v73, v64, v53 op_sel:[0,0] op_sel_hi:[0,1] neg_hi:[0,1]
    v_pk_fma_f16 v73, v64, v53, v73 op_sel:[1,1,0] op_sel_hi:[1,0,1]
    ds_write_addtid_b32 v73 offset:4624
    v_pk_mul_f16 v69, v65, v53 op_sel:[0,0] op_sel_hi:[0,1] neg_hi:[0,1]
    v_pk_fma_f16 v69, v65, v53, v69 op_sel:[1,1,0] op_sel_hi:[1,0,1]
    ds_write_addtid_b32 v69 offset:4896
    v_pk_mul_f16 v74, v56, v54 op_sel:[0,0] op_sel_hi:[0,1] neg_hi:[0,1]
    v_pk_fma_f16 v74, v56, v54, v74 op_sel:[1,1,0] op_sel_hi:[1,0,1]
    ds_write_addtid_b32 v74 offset:5168
    v_pk_mul_f16 v75, v62, v54 op_sel:[0,0] op_sel_hi:[0,1] neg_hi:[0,1]
    v_pk_fma_f16 v75, v62, v54, v75 op_sel:[1,1,0] op_sel_hi:[1,0,1]
    ds_write_addtid_b32 v75 offset:5440
    v_pk_mul_f16 v72, v63, v54 op_sel:[0,0] op_sel_hi:[0,1] neg_hi:[0,1]
    v_pk_fma_f16 v72, v63, v54, v72 op_sel:[1,1,0] op_sel_hi:[1,0,1]
    ds_write_addtid_b32 v72 offset:5712
    v_pk_mul_f16 v73, v65, v54 op_sel:[0,0] op_sel_hi:[0,1] neg_hi:[0,1]
    v_pk_fma_f16 v73, v65, v54, v73 op_sel:[1,1,0] op_sel_hi:[1,0,1]
    ds_write_addtid_b32 v73 offset:5984
    v_pk_mul_f16 v74, v66, v54 op_sel:[0,0] op_sel_hi:[0,1] neg_hi:[0,1]
    v_pk_fma_f16 v74, v66, v54, v74 op_sel:[1,1,0] op_sel_hi:[1,0,1]
    ds_write_addtid_b32 v74 offset:6256
    v_pk_mul_f16 v75, v67, v54 op_sel:[0,0] op_sel_hi:[0,1] neg_hi:[0,1]
    v_pk_fma_f16 v75, v67, v54, v75 op_sel:[1,1,0] op_sel_hi:[1,0,1]
    ds_write_addtid_b32 v75 offset:6528
    v_pk_mul_f16 v72, v68, v54 op_sel:[0,0] op_sel_hi:[0,1] neg_hi:[0,1]
    v_pk_fma_f16 v72, v68, v54, v72 op_sel:[1,1,0] op_sel_hi:[1,0,1]
    ds_write_addtid_b32 v72 offset:6800
    v_pk_mul_f16 v73, v69, v54 op_sel:[0,0] op_sel_hi:[0,1] neg_hi:[0,1]
    v_pk_fma_f16 v73, v69, v54, v73 op_sel:[1,1,0] op_sel_hi:[1,0,1]
    ds_write_addtid_b32 v73 offset:7072
    s_waitcnt lgkmcnt(0)
    s_barrier
    s_cbranch_vccz L_cons
    s_lshr_b32 s47, s40, 1
    s_mov_b32 s57, s44
    s_mov_b32 s52, s71
    s_add_u32 s44, s44, s47
    s_and_b32 s44, s44, 15
    s_mul_i32 s43, s47, 40960
    s_add_u32 s43, s43, 75776
    s_cmp_eq_u32 s47, 0
    s_cbranch_scc0 L_x0
    s_setprio 3
    s_lshl_b32 s47, s40, 10
    s_add_u32 m0, s47, 157696
    v_lshl_add_u32 v3, v2, 4, s47
    global_load_lds_dwordx4 v3, s[6:7]
L_x0:
    s_lshl_b32 s45, s44, 7
    s_mul_i32 s46, s44, 393216
    s_add_u32 m0, s41, s43
    s_nop 0
    buffer_load_dwordx4 v10, s[24:27], s45 offen lds
    s_add_u32 m0, m0, 1024
    s_add_u32 s44, s44, 1
    ds_read_b128 v[160:163], v28 offset:0
    ds_read_b128 v[164:167], v28 offset:32
    buffer_load_dwordx4 v11, s[24:27], s45 offen lds
    s_add_u32 m0, m0, 1024
    s_and_b32 s44, s44, 15
    ds_read_b128 v[168:171], v28 offset:64
    ds_read_b128 v[172:175], v28 offset:96
    buffer_load_dwordx4 v12, s[24:27], s45 offen lds
    s_add_u32 m0, m0, 1024
L_hop3:
    s_cbranch_execz L_hopback
    s_add_u32 s47, s46, 98304
    ds_read_b128 v[176:179], v28 offset:128
    ds_read_b128 v[180:183], v28 offset:160
    buffer_load_dwordx4 v13, s[24:27], s45 offen lds
    s_add_u32 m0, m0, 1024
    s_add_u32 s45, s45, 65536
    ds_read_b128 v[184:187], v28 offset:192
    ds_read_b128 v[188:191], v28 offset:224
    buffer_load_dwordx4 v10, s[24:27], s45 offen lds
    s_add_u32 m0, m0, 1024
    s_nop 0
    ds_read_b128 v[192:195], v28 offset:29376
    ds_read_b128 v[196:199], v28 offset:29408
    buffer_load_dwordx4 v11, s[24:27], s45 offen lds
    s_add_u32 m0, m0, 1024
    s_nop 0
    ds_read_b128 v[200:203], v28 offset:29440
    ds_read_b128 v[204:207], v28 offset:29472
    buffer_load_dwordx4 v12, s[24:27], s45 offen lds
    s_add_u32 m0, m0, 1024
    s_nop 0
    ds_read_b128 v[208:211], v28 offset:29504
    ds_read_b128 v[212:215], v28 offset:29536
    buffer_load_dwordx4 v13, s[24:27], s45 offen lds
    s_add_u32 m0, s42, s43
    s_add_u32 s43, s43, 40960
    ds_read_b128 v[216:219], v28 offset:29568
    ds_read_b128 v[220:223], v28 offset:29600
    buffer_load_dwordx4 v14, s[28:31], s46 offen lds
    s_add_u32 m0, m0, 1024
    s_cmp_eq_u32 s43, 157696
    s_cselect_b32 s43, 34816, s43
    buffer_load_dwordx4 v15, s[28:31], s46 offen lds
    s_add_u32 m0, m0, 1024
    s_lshl_b32 s45, s44, 7
    buffer_load_dwordx4 v14, s[28:31], s47 offen lds
    s_add_u32 m0, m0, 1024
    s_nop 0
    s_waitcnt lgkmcnt(15)
    v_mfma_f32_32x32x16_f16 v[80:95], v[160:163], v[96:99], 0
    buffer_load_dwordx4 v15, s[28:31], s47 offen lds
    s_add_u32 m0, m0, 5120
    s_nop 0
    s_waitcnt lgkmcnt(14)
    v_mfma_f32_32x32x16_f16 v[80:95], v[164:167], v[100:103], v[80:95]
    buffer_load_dwordx4 v16, s[28:31], s46 offen lds
    s_add_u32 m0, m0, 1024
    s_nop 0
    s_waitcnt lgkmcnt(13)
    v_mfma_f32_32x32x16_f16 v[80:95], v[168:171], v[104:107], v[80:95]
    buffer_load_dwordx4 v17, s[28:31], s46 offen lds
    s_add_u32 m0, m0, 1024
    s_nop 0
    s_waitcnt lgkmcnt(12)
    v_mfma_f32_32x32x16_f16 v[80:95], v[172:175], v[108:111], v[80:95]
    buffer_load_dwordx4 v16, s[28:31], s47 offen lds
    s_add_u32 m0, m0, 1024
    s_nop 0
    s_waitcnt lgkmcnt(11)
    v_mfma_f32_32x32x16_f16 v[80:95], v[176:179], v[112:115], v[80:95]
    buffer_load_dwordx4 v17, s[28:31], s47 offen lds
    s_add_u32 m0, m0, 5120
    s_nop 0
    s_waitcnt lgkmcnt(10)
    v_mfma_f32_32x32x16_f16 v[80:95], v[180:183], v[116:119], v[80:95]
    buffer_load_dwordx4 v18, s[28:31], s46 offen lds
    s_add_u32 m0, m0, 1024
    s_nop 0
    s_waitcnt lgkmcnt(9)
    v_mfma_f32_32x32x16_f16 v[80:95], v[184:187], v[120:123], v[80:95]
    buffer_load_dwordx4 v19, s[28:31], s46 offen lds
    s_add_u32 m0, m0, 1024
    s_nop 0
    s_waitcnt lgkmcnt(8)
    v_mfma_f32_32x32x16_f16 v[80:95], v[188:191], v[124:127], v[80:95]
    buffer_load_dwordx4 v18, s[28:31], s47 offen lds
    s_add_u32 m0, m0, 1024
    s_mul_i32 s46, s44, 393216
    s_waitcnt lgkmcnt(7)
    v_mfma_f32_32x32x16_f16 v[80:95], v[192:195], v[128:131], v[80:95]
    buffer_load_dwordx4 v19, s[28:31], s47 offen lds
    s_add_u32 m0, s41, s43
    s_waitcnt lgkmcnt(6)
    v_mfma_f32_32x32x16_f16 v[80:95], v[196:199], v[132:135], v[80:95]
    s_waitcnt lgkmcnt(5)
    v_mfma_f32_32x32x16_f16 v[80:95], v[200:203], v[136:139], v[80:95]
    s_waitcnt lgkmcnt(4)
    v_mfma_f32_32x32x16_f16 v[80:95], v[204:207], v[140:143], v[80:95]
    s_waitcnt lgkmcnt(3)
    v_mfma_f32_32x32x16_f16 v[80:95], v[208:211], v[144:147], v[80:95]
    s_waitcnt lgkmcnt(2)
    v_mfma_f32_32x32x16_f16 v[80:95], v[212:215], v[148:151], v[80:95]
    s_waitcnt lgkmcnt(1)
    v_mfma_f32_32x32x16_f16 v[80:95], v[216:219], v[152:155], v[80:95]
    s_waitcnt lgkmcnt(0)
    v_mfma_f32_32x32x16_f16 v[80:95], v[220:223], v[156:159], v[80:95]
    s_cmp_ge_u32 s40, 2
    s_cbranch_scc1 L_x1
    s_setprio 0
    s_add_u32 s44, s44, 1
    s_and_b32 s44, s44, 15
    s_mov_b32 s43, 34816
    s_mov_b32 s49, 0
    s_lshl_b32 s45, s44, 7
    s_mul_i32 s46, s44, 393216
    s_add_u32 m0, s41, s43
    s_waitcnt vmcnt(0)
L_hop4:
    s_cbranch_execz L_hopback
L_hl:
    s_waitcnt vmcnt(20)
    s_barrier
    buffer_load_dwordx4 v10, s[24:27], s45 offen lds
    s_add_u32 m0, m0, 1024
    s_add_u32 s44, s44, 1
    buffer_load_dwordx4 v11, s[24:27], s45 offen lds
    s_add_u32 m0, m0, 1024
    s_and_b32 s44, s44, 15
    buffer_load_dwordx4 v12, s[24:27], s45 offen lds
    s_add_u32 m0, m0, 1024
    s_add_u32 s47, s46, 98304
    buffer_load_dwordx4 v13, s[24:27], s45 offen lds
    s_add_u32 m0, m0, 1024
    s_add_u32 s45, s45, 65536
    buffer_load_dwordx4 v10, s[24:27], s45 offen lds
    s_add_u32 m0, m0, 1024
    s_nop 0
    buffer_load_dwordx4 v11, s[24:27], s45 offen lds
    s_add_u32 m0, m0, 1024
    s_nop 0
    buffer_load_dwordx4 v12, s[24:27], s45 offen lds
    s_add_u32 m0, m0, 1024
    s_add_u32 s49, s49, 1
    buffer_load_dwordx4 v13, s[24:27], s45 offen lds
    s_add_u32 m0, s42, s43
    s_add_u32 s43, s43, 40960
    buffer_load_dwordx4 v14, s[28:31], s46 offen lds
    s_add_u32 m0, m0, 1024
    s_cmp_eq_u32 s43, 157696
    s_cselect_b32 s43, 34816, s43
    buffer_load_dwordx4 v15, s[28:31], s46 offen lds
    s_add_u32 m0, m0, 1024
    s_lshl_b32 s45, s44, 7
    buffer_load_dwordx4 v14, s[28:31], s47 offen lds
    s_add_u32 m0, m0, 1024
    s_nop 0
    buffer_load_dwordx4 v15, s[28:31], s47 offen lds
    s_add_u32 m0, m0, 5120
    s_nop 0
    buffer_load_dwordx4 v16, s[28:31], s46 offen lds
    s_add_u32 m0, m0, 1024
    s_nop 0
    buffer_load_dwordx4 v17, s[28:31], s46 offen lds
    s_add_u32 m0, m0, 1024
    s_nop 0
    buffer_load_dwordx4 v16, s[28:31], s47 offen lds
    s_add_u32 m0, m0, 1024
    s_nop 0
    buffer_load_dwordx4 v17, s[28:31], s47 offen lds
    s_add_u32 m0, m0, 5120
    s_nop 0
    buffer_load_dwordx4 v18, s[28:31], s46 offen lds
    s_add_u32 m0, m0, 1024
    s_nop 0
    buffer_load_dwordx4 v19, s[28:31], s46 offen lds
    s_add_u32 m0, m0, 1024
    s_nop 0
    buffer_load_dwordx4 v18, s[28:31], s47 offen lds
    s_add_u32 m0, m0, 1024
    s_mul_i32 s46, s44, 393216
    buffer_load_dwordx4 v19, s[28:31], s47 offen lds
    s_add_u32 m0, s41, s43
    s_cmp_lt_u32 s49, 14
    s_cbranch_scc1 L_hl
L_hop5:
    s_cbranch_execz L_hopback
    s_waitcnt vmcnt(20)
    s_barrier
    v_lshrrev_b32 v3, 3, v2
    v_and_b32 v4, 7, v2
    v_bfe_u32 v5, v3, 1, 1
    v_lshlrev_b32 v5, 2, v5
    v_xor_b32 v4, v4, v5
    v_lshlrev_b32 v3, 11, v3
    s_lshl_b32 s47, s97, 7
    v_add_u32 v3, s47, v3
    v_lshl_add_u32 v8, v4, 4, v3
    v_add_u32 v9, 16384, v8
    s_lshl_b32 s48, s40, 1
    s_add_u32 s49, s48, 1
    s_lshl_b32 s45, s48, 13
    s_add_u32 m0, s45, 116736
    s_lshl_b32 s45, s98, 1
    s_add_u32 s45, s45, s48
    s_add_u32 s45, s45, 0
    s_and_b32 s45, s45, 15
    s_lshl_b32 s45, s45, 17
    buffer_load_dwordx4 v8, s[36:39], s45 offen lds
    s_add_u32 m0, m0, 1024
    v_mul_f32 v30, s52, v30
    v_lshlrev_b32 v31, 16, v31
    buffer_load_dwordx4 v9, s[36:39], s45 offen lds
    s_add_u32 m0, m0, 1024
    s_add_u32 s45, s45, 32768
    v_cmp_eq_u32 vcc, 0, v2
    v_add_f32 v30, v30, v30
    buffer_load_dwordx4 v8, s[36:39], s45 offen lds
    s_add_u32 m0, m0, 1024
    v_mul_f32 v81, v30, v81
    v_cndmask_b32 v3, 0, v31, vcc
    buffer_load_dwordx4 v9, s[36:39], s45 offen lds
    s_add_u32 m0, m0, 1024
    s_add_u32 s45, s45, 32768
    v_fma_f32 v80, v30, v80, v3
    v_mul_f32 v82, v30, v82
    buffer_load_dwordx4 v8, s[36:39], s45 offen lds
    s_add_u32 m0, m0, 1024
    v_mul_f32 v83, v30, v83
    v_mul_f32 v84, v30, v84
    buffer_load_dwordx4 v9, s[36:39], s45 offen lds
    s_add_u32 m0, m0, 1024
    s_add_u32 s45, s45, 32768
    v_mul_f32 v85, v30, v85
    v_mul_f32 v86, v30, v86
    buffer_load_dwordx4 v8, s[36:39], s45 offen lds
    s_add_u32 m0, m0, 1024
    v_mul_f32 v88, v30, v88
    v_mul_f32 v89, v30, v89
    buffer_load_dwordx4 v9, s[36:39], s45 offen lds
    s_lshl_b32 s45, s49, 13
    s_add_u32 m0, s45, 116736
    s_lshl_b32 s45, s98, 1
    s_add_u32 s45, s45, s49
    s_add_u32 s45, s45, 0
    s_and_b32 s45, s45, 15
    s_lshl_b32 s45, s45, 17
    v_mul_f32 v90, v30, v90
    v_mul_f32 v92, v30, v92
    buffer_load_dwordx4 v8, s[36:39], s45 offen lds
    s_add_u32 m0, m0, 1024
    v_mul_f32 v93, v30, v93
    v_mul_f32 v94, v30, v94
    buffer_load_dwordx4 v9, s[36:39], s45 offen lds
    s_add_u32 m0, m0, 1024
    s_add_u32 s45, s45, 32768
    v_mul_f32 v95, v30, v95
    v_and_b32 v7, 1, v2
    buffer_load_dwordx4 v8, s[36:39], s45 offen lds
    s_add_u32 m0, m0, 1024
    s_nop 0
    buffer_load_dwordx4 v9, s[36:39], s45 offen lds
    s_add_u32 m0, m0, 1024
    s_add_u32 s45, s45, 32768
    buffer_load_dwordx4 v8, s[36:39], s45 offen lds
    s_add_u32 m0, m0, 1024
    s_nop 0
    buffer_load_dwordx4 v9, s[36:39], s45 offen lds
    s_add_u32 m0, m0, 1024
    s_add_u32 s45, s45, 32768
    buffer_load_dwordx4 v8, s[36:39], s45 offen lds
    s_add_u32 m0, m0, 1024
    s_nop 0
    buffer_load_dwordx4 v9, s[36:39], s45 offen lds
    s_waitcnt vmcnt(16)
    s_barrier
    s_lshl_b32 s45, s48, 13
    s_add_u32 m0, s45, 34816
    s_lshl_b32 s45, s98, 1
    s_add_u32 s45, s45, s48
    s_add_u32 s45, s45, 4
    s_and_b32 s45, s45, 15
    s_lshl_b32 s45, s45, 17
    buffer_load_dwordx4 v8, s[36:39], s45 offen lds
    s_add_u32 m0, m0, 1024
    v_cmp_eq_u32 s[18:19], 1, v7
    v_cvt_pk_bf16_f32 v224, v80, v81
    buffer_load_dwordx4 v9, s[36:39], s45 offen lds
    s_add_u32 m0, m0, 1024
    s_add_u32 s45, s45, 32768
    v_cvt_pk_bf16_f32 v225, v82, v83
    v_cvt_pk_bf16_f32 v226, v84, v84
    buffer_load_dwordx4 v8, s[36:39], s45 offen lds
    s_add_u32 m0, m0, 1024
    v_cvt_pk_bf16_f32 v227, v85, v86
    v_cvt_pk_bf16_f32 v228, v88, v88
    buffer_load_dwordx4 v9, s[36:39], s45 offen lds
    s_add_u32 m0, m0, 1024
    s_add_u32 s45, s45, 32768
    v_cvt_pk_bf16_f32 v229, v88, v89
    v_cvt_pk_bf16_f32 v230, v89, v89
    buffer_load_dwordx4 v8, s[36:39], s45 offen lds
    s_add_u32 m0, m0, 1024
    v_cvt_pk_bf16_f32 v231, v90, v90
    v_cndmask_b32 v3, v92, v93, s[18:19]
    buffer_load_dwordx4 v9, s[36:39], s45 offen lds
    s_add_u32 m0, m0, 1024
    s_add_u32 s45, s45, 32768
    v_cvt_pk_bf16_f32 v232, v92, v92
    v_cvt_pk_bf16_f32 v235, v93, v93
    buffer_load_dwordx4 v8, s[36:39], s45 offen lds
    s_add_u32 m0, m0, 1024
    v_cvt_pk_bf16_f32 v234, v3, v93
    v_mov_b32 v233, v232
    buffer_load_dwordx4 v9, s[36:39], s45 offen lds
    s_lshl_b32 s45, s49, 13
    s_add_u32 m0, s45, 34816
    s_lshl_b32 s45, s98, 1
    s_add_u32 s45, s45, s49
    s_add_u32 s45, s45, 4
    s_and_b32 s45, s45, 15
    s_lshl_b32 s45, s45, 17
    v_cndmask_b32 v3, v94, v95, s[18:19]
    v_cvt_pk_bf16_f32 v236, v94, v94
    buffer_load_dwordx4 v8, s[36:39], s45 offen lds
    s_add_u32 m0, m0, 1024
    v_cvt_pk_bf16_f32 v239, v95, v95
    v_cvt_pk_bf16_f32 v238, v3, v95
    buffer_load_dwordx4 v9, s[36:39], s45 offen lds
    s_add_u32 m0, m0, 1024
L_hop6:
    s_cbranch_execz L_hopback
    s_add_u32 s45, s45, 32768
    v_mov_b32 v237, v236
    buffer_load_dwordx4 v8, s[36:39], s45 offen lds
    s_add_u32 m0, m0, 1024
    s_nop 0
    buffer_load_dwordx4 v9, s[36:39], s45 offen lds
    s_add_u32 m0, m0, 1024
    s_add_u32 s45, s45, 32768
    buffer_load_dwordx4 v8, s[36:39], s45 offen lds
    s_add_u32 m0, m0, 1024
    s_nop 0
    buffer_load_dwordx4 v9, s[36:39], s45 offen lds
    s_add_u32 m0, m0, 1024
    s_add_u32 s45, s45, 32768
    buffer_load_dwordx4 v8, s[36:39], s45 offen lds
    s_add_u32 m0, m0, 1024
    s_nop 0
    buffer_load_dwordx4 v9, s[36:39], s45 offen lds
    s_load_dword s54, s[12:13], 0
    s_waitcnt lgkmcnt(0)
    s_branch L_hfin
L_x1:
    s_mov_b32 s49, 0
    s_barrier
    s_call_b64 s[70:71], L_aux0
    s_waitcnt vmcnt(0)
    s_call_b64 s[70:71], L_aux
    v_lshrrev_b32 v3, 3, v2
    v_and_b32 v4, 7, v2
    v_bfe_u32 v5, v3, 1, 1
    v_lshlrev_b32 v5, 2, v5
    v_xor_b32 v4, v4, v5
    v_lshlrev_b32 v3, 11, v3
    s_lshl_b32 s47, s97, 7
    v_add_u32 v3, s47, v3
    v_lshl_add_u32 v10, v4, 4, v3
    v_add_u32 v11, 16384, v10
    s_call_b64 s[70:71], L_aux
    v_mul_f32 v30, s52, v30
    v_lshlrev_b32 v31, 16, v31
    v_cmp_eq_u32 vcc, 0, v2
    v_add_f32 v30, v30, v30
    v_mul_f32 v81, v30, v81
    v_cndmask_b32 v3, 0, v31, vcc
    v_fma_f32 v80, v30, v80, v3
    v_mul_f32 v82, v30, v82
    v_mul_f32 v83, v30, v83
    v_mul_f32 v84, v30, v84
    v_mul_f32 v85, v30, v85
    v_mul_f32 v86, v30, v86
    v_mul_f32 v88, v30, v88
    v_mul_f32 v89, v30, v89
    v_mul_f32 v90, v30, v90
    v_mul_f32 v92, v30, v92
    v_mul_f32 v93, v30, v93
    v_mul_f32 v94, v30, v94
    v_mul_f32 v95, v30, v95
    v_and_b32 v7, 1, v2
    v_cmp_eq_u32 s[18:19], 1, v7
    v_cvt_pk_bf16_f32 v224, v80, v81
    v_cvt_pk_bf16_f32 v225, v82, v83
    v_cvt_pk_bf16_f32 v226, v84, v84
    v_cvt_pk_bf16_f32 v227, v85, v86
    v_cvt_pk_bf16_f32 v228, v88, v88
    v_cvt_pk_bf16_f32 v229, v88, v89
    v_cvt_pk_bf16_f32 v230, v89, v89
    v_cvt_pk_bf16_f32 v231, v90, v90
    v_cndmask_b32 v3, v92, v93, s[18:19]
    v_cvt_pk_bf16_f32 v232, v92, v92
    v_cvt_pk_bf16_f32 v235, v93, v93
    v_cvt_pk_bf16_f32 v234, v3, v93
    v_mov_b32 v233, v232
    v_cndmask_b32 v3, v94, v95, s[18:19]
    v_cvt_pk_bf16_f32 v236, v94, v94
    v_cvt_pk_bf16_f32 v239, v95, v95
    v_cvt_pk_bf16_f32 v238, v3, v95
    v_mov_b32 v237, v236
L_auxrest:
    s_call_b64 s[70:71], L_aux
    s_cmp_lt_u32 s49, 16
    s_cbranch_scc1 L_auxrest
    s_waitcnt vmcnt(0) lgkmcnt(0)
    v_lshlrev_b32 v68, 16, v64
    v_lshlrev_b32 v69, 16, v66
    v_and_b32 v70, 0xffff0000, v64
    v_and_b32 v71, 0xffff0000, v66
    v_fmac_f32 v76, v68, v69
    v_fmac_f32 v76, v70, v71
    v_lshlrev_b32 v68, 16, v65
    v_lshlrev_b32 v69, 16, v67
    v_and_b32 v70, 0xffff0000, v65
    v_and_b32 v71, 0xffff0000, v67
    v_fmac_f32 v76, v68, v69
    v_fmac_f32 v76, v70, v71
    s_nop 1
    v_add_f32_dpp v76, v76, v76 row_ror:8 row_mask:0xf bank_mask:0xf
    s_nop 1
    v_add_f32_dpp v76, v76, v76 row_ror:4 row_mask:0xf bank_mask:0xf
    s_nop 1
    v_add_f32_dpp v76, v76, v76 row_ror:2 row_mask:0xf bank_mask:0xf
    s_nop 1
    v_add_f32_dpp v76, v76, v76 row_ror:1 row_mask:0xf bank_mask:0xf
    v_mul_f32 v76, 3216550459, v76
    v_exp_f32 v76, v76
    v_lshrrev_b32 v4, 4, v2
    v_add_f32 v76, 1.0, v76
    v_lshlrev_b32 v4, 2, v4
    v_rcp_f32 v27, v76
    v_and_b32 v5, 15, v2
    v_lshl_add_u32 v4, v5, 26, v4
    s_lshl_b32 s45, s20, 4
    s_add_u32 s45, s45, s21
    s_lshl_b32 s45, s45, 1
    s_add_u32 s45, s45, s58
    s_lshl_b32 s45, s45, 4
    s_add_u32 s45, s45, 17891328
    buffer_store_dword v27, v4, s[32:35], s45 offen sc1
    v_mov_b64 v[8:9], v[10:11]
L_hfin:
    s_barrier
    s_lshl_b32 s45, s40, 13
    s_add_u32 m0, s45, 75776
    s_lshl_b32 s45, s98, 1
    s_add_u32 s45, s45, s40
    s_add_u32 s45, s45, 8
    s_and_b32 s45, s45, 15
    s_lshl_b32 s45, s45, 17
    buffer_load_dwordx4 v8, s[36:39], s45 offen lds
    s_add_u32 m0, m0, 1024
    ds_read_b64 v[104:105], v245 offset:1024
    ds_read_b64 v[106:107], v246 offset:1024
    ds_read_b64 v[108:109], v247 offset:1024
    ds_read_b64 v[110:111], v248 offset:1024
    ds_read_b64 v[112:113], v245 offset:2048
    ds_read_b64 v[114:115], v246 offset:2048
    buffer_load_dwordx4 v9, s[36:39], s45 offen lds
    s_add_u32 m0, m0, 1024
    s_add_u32 s45, s45, 32768
    ds_read_b64 v[116:117], v247 offset:2048
    ds_read_b64 v[118:119], v248 offset:2048
    ds_read_b64 v[120:121], v245 offset:3072
    ds_read_b64 v[122:123], v246 offset:3072
    ds_read_b64 v[124:125], v247 offset:3072
    ds_read_b64 v[126:127], v248 offset:3072
    buffer_load_dwordx4 v8, s[36:39], s45 offen lds
    s_add_u32 m0, m0, 1024
    ds_read_b64 v[128:129], v245 offset:4096
    ds_read_b64 v[130:131], v246 offset:4096
    ds_read_b64 v[132:133], v247 offset:4096
    ds_read_b64 v[134:135], v248 offset:4096
    ds_read_b64 v[136:137], v245 offset:5120
    ds_read_b64 v[138:139], v246 offset:5120
    buffer_load_dwordx4 v9, s[36:39], s45 offen lds
    s_add_u32 m0, m0, 1024
    s_add_u32 s45, s45, 32768
    ds_read_b64 v[140:141], v247 offset:5120
    ds_read_b64 v[142:143], v248 offset:5120
    ds_read_b64 v[144:145], v245 offset:6144
    ds_read_b64 v[146:147], v246 offset:6144
    ds_read_b64 v[148:149], v247 offset:6144
    ds_read_b64 v[150:151], v248 offset:6144
    buffer_load_dwordx4 v8, s[36:39], s45 offen lds
    s_add_u32 m0, m0, 1024
    ds_read_b64 v[152:153], v245 offset:7168
    ds_read_b64 v[154:155], v246 offset:7168
    ds_read_b64 v[156:157], v247 offset:7168
    ds_read_b64 v[158:159], v248 offset:7168
    ds_read_b64 v[160:161], v245 offset:8192
L_hop7:
    s_cbranch_execz L_hopback
    ds_read_b64 v[162:163], v246 offset:8192
    buffer_load_dwordx4 v9, s[36:39], s45 offen lds
    s_add_u32 m0, m0, 1024
    s_add_u32 s45, s45, 32768
    ds_read_b64 v[164:165], v247 offset:8192
    ds_read_b64 v[166:167], v248 offset:8192
    ds_read_b64 v[168:169], v245 offset:9216
    ds_read_b64 v[170:171], v246 offset:9216
    ds_read_b64 v[172:173], v247 offset:9216
    ds_read_b64 v[174:175], v248 offset:9216
    buffer_load_dwordx4 v8, s[36:39], s45 offen lds
    s_add_u32 m0, m0, 1024
    ds_read_b64 v[176:177], v245 offset:10240
    ds_read_b64 v[178:179], v246 offset:10240
    ds_read_b64 v[180:181], v247 offset:10240
    ds_read_b64 v[182:183], v248 offset:10240
    ds_read_b64 v[184:185], v245 offset:11264
    ds_read_b64 v[186:187], v246 offset:11264
    buffer_load_dwordx4 v9, s[36:39], s45 offen lds
    ds_read_b64 v[188:189], v247 offset:11264
    ds_read_b64 v[190:191], v248 offset:11264
    ds_read_b64 v[192:193], v245 offset:12288
    ds_read_b64 v[194:195], v246 offset:12288
    ds_read_b64 v[196:197], v247 offset:12288
    ds_read_b64 v[198:199], v248 offset:12288
    ds_read_b64 v[200:201], v245 offset:13312
    ds_read_b64 v[202:203], v246 offset:13312
    ds_read_b64 v[204:205], v247 offset:13312
    ds_read_b64 v[206:207], v248 offset:13312
    ds_read_b64 v[208:209], v245 offset:14336
    ds_read_b64 v[210:211], v246 offset:14336
    ds_read_b64 v[212:213], v247 offset:14336
    ds_read_b64 v[214:215], v248 offset:14336
    ds_read_b64 v[216:217], v245 offset:15360
    ds_read_b64 v[218:219], v246 offset:15360
    ds_read_b64 v[220:221], v247 offset:15360
    ds_read_b64 v[222:223], v248 offset:15360
    s_waitcnt vmcnt(0)
    v_mov_b64 v[4:5], 0
    v_mov_b64 v[6:7], 0
    ds_write_b32 v243, v4
    ds_write_b128 v24, v[4:7] offset:16640
    ds_write_b64 v240, v[224:225] offset:32
    ds_write_b64 v240, v[226:227] offset:544
    ds_write_b128 v241, v[228:231] offset:1056
    ds_write_b128 v242, v[232:235] offset:2080
    ds_write_b128 v242, v[236:239] offset:2592
    ds_read_b64 v[96:97], v245 offset:0
    ds_read_b64 v[98:99], v246 offset:0
    ds_read_b64 v[100:101], v247 offset:0
    ds_read_b64 v[102:103], v248 offset:0
    ds_read_b64_tr_b16 v[32:33], v244 offset:32
    ds_read_b64_tr_b16 v[34:35], v244 offset:0
    ds_read_b64_tr_b16 v[36:37], v244 offset:288
    ds_read_b64_tr_b16 v[38:39], v244 offset:256
    ds_read_b64_tr_b16 v[40:41], v244 offset:544
    ds_read_b64_tr_b16 v[42:43], v244 offset:512
    ds_read_b64_tr_b16 v[44:45], v244 offset:800
    ds_read_b64_tr_b16 v[46:47], v244 offset:768
    ds_read_b64_tr_b16 v[48:49], v244 offset:1056
    ds_read_b64_tr_b16 v[50:51], v244 offset:1024
    ds_read_b64_tr_b16 v[52:53], v244 offset:1312
    ds_read_b64_tr_b16 v[54:55], v244 offset:1280
    ds_read_b64_tr_b16 v[56:57], v244 offset:1568
    ds_read_b64_tr_b16 v[58:59], v244 offset:1536
    ds_read_b64_tr_b16 v[60:61], v244 offset:1824
    ds_read_b64_tr_b16 v[62:63], v244 offset:1792
    ds_read_b64_tr_b16 v[64:65], v244 offset:2080
    ds_read_b64_tr_b16 v[66:67], v244 offset:2048
    ds_read_b64_tr_b16 v[68:69], v244 offset:2336
    ds_read_b64_tr_b16 v[70:71], v244 offset:2304
    ds_read_b64_tr_b16 v[72:73], v244 offset:2592
    ds_read_b64_tr_b16 v[74:75], v244 offset:2560
    ds_read_b64_tr_b16 v[76:77], v244 offset:2848
    ds_read_b64_tr_b16 v[78:79], v244 offset:2816
    ds_read_b64_tr_b16 v[80:81], v244 offset:3104
    ds_read_b64_tr_b16 v[82:83], v244 offset:3072
    ds_read_b64_tr_b16 v[84:85], v244 offset:3360
    ds_read_b64_tr_b16 v[86:87], v244 offset:3328
    ds_read_b64_tr_b16 v[88:89], v244 offset:3616
    ds_read_b64_tr_b16 v[90:91], v244 offset:3584
    ds_read_b64_tr_b16 v[92:93], v244 offset:3872
    ds_read_b64_tr_b16 v[94:95], v244 offset:3840
    v_mov_b32 v4, 163592
    s_mov_b32 s16, 200000
L_lw16:
    ds_read_b32 v5, v4
    s_sub_u32 s16, s16, 1
    s_cbranch_scc1 L_ld17
    s_waitcnt lgkmcnt(0)
    v_cmp_gt_u32 vcc, 4, v5
    s_cbranch_vccnz L_lw16
L_ld17:
    v_mfma_f32_16x16x32_bf16 v[224:227], v[96:99], v[32:35], 0
    v_mfma_f32_16x16x32_bf16 v[228:231], v[100:103], v[32:35], 0
    s_waitcnt vmcnt(0)
    v_mov_b32 v3, 163608
    v_mov_b32 v4, 1
    s_mov_b64 exec, 1
    ds_add_u32 v3, v4
    s_mov_b64 exec, -1
    v_mfma_f32_16x16x32_bf16 v[232:235], v[104:107], v[32:35], 0
    v_add_f32_dpp v240, v227, v226 wave_shr:1 row_mask:0xf bank_mask:0xf bound_ctrl:1
    s_nop 1
    v_add_f32_dpp v242, v240, v225 wave_shr:1 row_mask:0xf bank_mask:0xf bound_ctrl:1
    v_mfma_f32_16x16x32_bf16 v[232:235], v[96:99], v[36:39], v[232:235]
    s_nop 0
    v_add_f32_dpp v244, v242, v224 wave_shr:1 row_mask:0xf bank_mask:0xf bound_ctrl:1
    v_mfma_f32_16x16x32_bf16 v[236:239], v[108:111], v[32:35], 0
    v_add_f32_dpp v241, v227, v230 wave_ror:1 row_mask:0xf bank_mask:0xf
    v_add_f32_dpp v243, v240, v229 wave_ror:1 row_mask:0xf bank_mask:0xf
    v_add_f32_dpp v245, v242, v228 wave_ror:1 row_mask:0xf bank_mask:0xf
    v_add_f32_dpp v241, v231, v230 wave_shr:1 row_mask:0xf bank_mask:0xf
    v_mfma_f32_16x16x32_bf16 v[236:239], v[100:103], v[36:39], v[236:239]
    s_nop 0
    v_add_f32_dpp v243, v241, v229 wave_shr:1 row_mask:0xf bank_mask:0xf
    s_nop 1
    v_add_f32_dpp v245, v243, v228 wave_shr:1 row_mask:0xf bank_mask:0xf
    v_cvt_pk_bf16_f32 v8, v244, v245
    v_mfma_f32_16x16x32_bf16 v[224:227], v[112:115], v[32:35], 0
    v_add_f32_dpp v240, v231, v234 wave_ror:1 row_mask:0xf bank_mask:0xf
    v_add_f32_dpp v242, v241, v233 wave_ror:1 row_mask:0xf bank_mask:0xf
    v_mfma_f32_16x16x32_bf16 v[224:227], v[104:107], v[36:39], v[224:227]
    v_add_f32_dpp v244, v243, v232 wave_ror:1 row_mask:0xf bank_mask:0xf
    v_add_f32_dpp v240, v235, v234 wave_shr:1 row_mask:0xf bank_mask:0xf
    v_mfma_f32_16x16x32_bf16 v[224:227], v[96:99], v[40:43], v[224:227]
    s_nop 0
    v_add_f32_dpp v242, v240, v233 wave_shr:1 row_mask:0xf bank_mask:0xf
    s_nop 1
    v_add_f32_dpp v244, v242, v232 wave_shr:1 row_mask:0xf bank_mask:0xf
    v_mfma_f32_16x16x32_bf16 v[228:231], v[116:119], v[32:35], 0
    v_add_f32_dpp v241, v235, v238 wave_ror:1 row_mask:0xf bank_mask:0xf
    v_add_f32_dpp v243, v240, v237 wave_ror:1 row_mask:0xf bank_mask:0xf
    v_add_f32_dpp v245, v242, v236 wave_ror:1 row_mask:0xf bank_mask:0xf
    v_mfma_f32_16x16x32_bf16 v[228:231], v[108:111], v[36:39], v[228:231]
    v_add_f32_dpp v241, v239, v238 wave_shr:1 row_mask:0xf bank_mask:0xf
    s_nop 1
    v_add_f32_dpp v243, v241, v237 wave_shr:1 row_mask:0xf bank_mask:0xf
    s_nop 1
    v_add_f32_dpp v245, v243, v236 wave_shr:1 row_mask:0xf bank_mask:0xf
L_hop8:
    s_cbranch_execz L_hopback
    v_mfma_f32_16x16x32_bf16 v[228:231], v[100:103], v[40:43], v[228:231]
    v_cvt_pk_bf16_f32 v9, v244, v245
    v_mfma_f32_16x16x32_bf16 v[232:235], v[120:123], v[32:35], 0
    v_add_f32_dpp v240, v239, v226 wave_ror:1 row_mask:0xf bank_mask:0xf
    v_add_f32_dpp v242, v241, v225 wave_ror:1 row_mask:0xf bank_mask:0xf
    v_mfma_f32_16x16x32_bf16 v[232:235], v[112:115], v[36:39], v[232:235]
    v_add_f32_dpp v244, v243, v224 wave_ror:1 row_mask:0xf bank_mask:0xf
    v_add_f32_dpp v240, v227, v226 wave_shr:1 row_mask:0xf bank_mask:0xf
    v_mfma_f32_16x16x32_bf16 v[232:235], v[104:107], v[40:43], v[232:235]
    s_nop 0
    v_add_f32_dpp v242, v240, v225 wave_shr:1 row_mask:0xf bank_mask:0xf
    s_nop 1
    v_add_f32_dpp v244, v242, v224 wave_shr:1 row_mask:0xf bank_mask:0xf
    v_mfma_f32_16x16x32_bf16 v[232:235], v[96:99], v[44:47], v[232:235]
    v_mfma_f32_16x16x32_bf16 v[236:239], v[124:127], v[32:35], 0
    v_add_f32_dpp v241, v227, v230 wave_ror:1 row_mask:0xf bank_mask:0xf
    v_add_f32_dpp v243, v240, v229 wave_ror:1 row_mask:0xf bank_mask:0xf
    v_mfma_f32_16x16x32_bf16 v[236:239], v[116:119], v[36:39], v[236:239]
    v_add_f32_dpp v245, v242, v228 wave_ror:1 row_mask:0xf bank_mask:0xf
    v_add_f32_dpp v241, v231, v230 wave_shr:1 row_mask:0xf bank_mask:0xf
    v_mfma_f32_16x16x32_bf16 v[236:239], v[108:111], v[40:43], v[236:239]
    s_nop 0
    v_add_f32_dpp v243, v241, v229 wave_shr:1 row_mask:0xf bank_mask:0xf
    s_nop 1
    v_add_f32_dpp v245, v243, v228 wave_shr:1 row_mask:0xf bank_mask:0xf
    v_mfma_f32_16x16x32_bf16 v[236:239], v[100:103], v[44:47], v[236:239]
    v_cvt_pk_bf16_f32 v10, v244, v245
    v_mfma_f32_16x16x32_bf16 v[224:227], v[128:131], v[32:35], 0
    v_add_f32_dpp v240, v231, v234 wave_ror:1 row_mask:0xf bank_mask:0xf
    v_add_f32_dpp v242, v241, v233 wave_ror:1 row_mask:0xf bank_mask:0xf
    v_mfma_f32_16x16x32_bf16 v[224:227], v[120:123], v[36:39], v[224:227]
    v_add_f32_dpp v244, v243, v232 wave_ror:1 row_mask:0xf bank_mask:0xf
    v_add_f32_dpp v240, v235, v234 wave_shr:1 row_mask:0xf bank_mask:0xf
    v_mfma_f32_16x16x32_bf16 v[224:227], v[112:115], v[40:43], v[224:227]
    s_nop 0
    v_add_f32_dpp v242, v240, v233 wave_shr:1 row_mask:0xf bank_mask:0xf
    s_nop 1
    v_add_f32_dpp v244, v242, v232 wave_shr:1 row_mask:0xf bank_mask:0xf
    v_mfma_f32_16x16x32_bf16 v[224:227], v[104:107], v[44:47], v[224:227]
    v_mfma_f32_16x16x32_bf16 v[224:227], v[96:99], v[48:51], v[224:227]
    v_mfma_f32_16x16x32_bf16 v[228:231], v[132:135], v[32:35], 0
    v_add_f32_dpp v241, v235, v238 wave_ror:1 row_mask:0xf bank_mask:0xf
    v_add_f32_dpp v243, v240, v237 wave_ror:1 row_mask:0xf bank_mask:0xf
    v_mfma_f32_16x16x32_bf16 v[228:231], v[124:127], v[36:39], v[228:231]
    v_add_f32_dpp v245, v242, v236 wave_ror:1 row_mask:0xf bank_mask:0xf
    v_add_f32_dpp v241, v239, v238 wave_shr:1 row_mask:0xf bank_mask:0xf
    v_mfma_f32_16x16x32_bf16 v[228:231], v[116:119], v[40:43], v[228:231]
    s_nop 0
    v_add_f32_dpp v243, v241, v237 wave_shr:1 row_mask:0xf bank_mask:0xf
    s_nop 1
    v_add_f32_dpp v245, v243, v236 wave_shr:1 row_mask:0xf bank_mask:0xf
    v_mfma_f32_16x16x32_bf16 v[228:231], v[108:111], v[44:47], v[228:231]
    v_cvt_pk_bf16_f32 v11, v244, v245
    v_mfma_f32_16x16x32_bf16 v[228:231], v[100:103], v[48:51], v[228:231]
    v_mfma_f32_16x16x32_bf16 v[232:235], v[136:139], v[32:35], 0
    v_add_f32_dpp v240, v239, v226 wave_ror:1 row_mask:0xf bank_mask:0xf
    v_mfma_f32_16x16x32_bf16 v[232:235], v[128:131], v[36:39], v[232:235]
    v_add_f32_dpp v242, v241, v225 wave_ror:1 row_mask:0xf bank_mask:0xf
    v_mfma_f32_16x16x32_bf16 v[232:235], v[120:123], v[40:43], v[232:235]
    v_add_f32_dpp v244, v243, v224 wave_ror:1 row_mask:0xf bank_mask:0xf
    v_mfma_f32_16x16x32_bf16 v[232:235], v[112:115], v[44:47], v[232:235]
    v_add_f32_dpp v240, v227, v226 wave_shr:1 row_mask:0xf bank_mask:0xf
    v_mfma_f32_16x16x32_bf16 v[232:235], v[104:107], v[48:51], v[232:235]
    s_nop 0
    v_add_f32_dpp v242, v240, v225 wave_shr:1 row_mask:0xf bank_mask:0xf
    v_mfma_f32_16x16x32_bf16 v[232:235], v[96:99], v[52:55], v[232:235]
    s_nop 0
    v_add_f32_dpp v244, v242, v224 wave_shr:1 row_mask:0xf bank_mask:0xf
    v_mfma_f32_16x16x32_bf16 v[236:239], v[140:143], v[32:35], 0
    v_add_f32_dpp v241, v227, v230 wave_ror:1 row_mask:0xf bank_mask:0xf
    v_add_f32_dpp v243, v240, v229 wave_ror:1 row_mask:0xf bank_mask:0xf
    v_mfma_f32_16x16x32_bf16 v[236:239], v[132:135], v[36:39], v[236:239]
    v_add_f32_dpp v245, v242, v228 wave_ror:1 row_mask:0xf bank_mask:0xf
    v_add_f32_dpp v241, v231, v230 wave_shr:1 row_mask:0xf bank_mask:0xf
    v_mfma_f32_16x16x32_bf16 v[236:239], v[124:127], v[40:43], v[236:239]
    s_nop 0
    v_add_f32_dpp v243, v241, v229 wave_shr:1 row_mask:0xf bank_mask:0xf
    s_nop 1
    v_add_f32_dpp v245, v243, v228 wave_shr:1 row_mask:0xf bank_mask:0xf
    v_mfma_f32_16x16x32_bf16 v[236:239], v[116:119], v[44:47], v[236:239]
    v_cvt_pk_bf16_f32 v12, v244, v245
    v_mfma_f32_16x16x32_bf16 v[236:239], v[108:111], v[48:51], v[236:239]
    v_mfma_f32_16x16x32_bf16 v[236:239], v[100:103], v[52:55], v[236:239]
    v_mfma_f32_16x16x32_bf16 v[224:227], v[144:147], v[32:35], 0
    v_add_f32_dpp v240, v231, v234 wave_ror:1 row_mask:0xf bank_mask:0xf
    v_mfma_f32_16x16x32_bf16 v[224:227], v[136:139], v[36:39], v[224:227]
    v_add_f32_dpp v242, v241, v233 wave_ror:1 row_mask:0xf bank_mask:0xf
    v_mfma_f32_16x16x32_bf16 v[224:227], v[128:131], v[40:43], v[224:227]
    v_add_f32_dpp v244, v243, v232 wave_ror:1 row_mask:0xf bank_mask:0xf
    v_mfma_f32_16x16x32_bf16 v[224:227], v[120:123], v[44:47], v[224:227]
    v_add_f32_dpp v240, v235, v234 wave_shr:1 row_mask:0xf bank_mask:0xf
    v_mfma_f32_16x16x32_bf16 v[224:227], v[112:115], v[48:51], v[224:227]
    s_nop 0
    v_add_f32_dpp v242, v240, v233 wave_shr:1 row_mask:0xf bank_mask:0xf
    v_mfma_f32_16x16x32_bf16 v[224:227], v[104:107], v[52:55], v[224:227]
    s_nop 0
    v_add_f32_dpp v244, v242, v232 wave_shr:1 row_mask:0xf bank_mask:0xf
    v_mfma_f32_16x16x32_bf16 v[224:227], v[96:99], v[56:59], v[224:227]
    v_mfma_f32_16x16x32_bf16 v[228:231], v[148:151], v[32:35], 0
    v_add_f32_dpp v241, v235, v238 wave_ror:1 row_mask:0xf bank_mask:0xf
    v_mfma_f32_16x16x32_bf16 v[228:231], v[140:143], v[36:39], v[228:231]
    v_add_f32_dpp v243, v240, v237 wave_ror:1 row_mask:0xf bank_mask:0xf
    v_mfma_f32_16x16x32_bf16 v[228:231], v[132:135], v[40:43], v[228:231]
    v_add_f32_dpp v245, v242, v236 wave_ror:1 row_mask:0xf bank_mask:0xf
    v_mfma_f32_16x16x32_bf16 v[228:231], v[124:127], v[44:47], v[228:231]
    v_add_f32_dpp v241, v239, v238 wave_shr:1 row_mask:0xf bank_mask:0xf
    v_mfma_f32_16x16x32_bf16 v[228:231], v[116:119], v[48:51], v[228:231]
    s_nop 0
    v_add_f32_dpp v243, v241, v237 wave_shr:1 row_mask:0xf bank_mask:0xf
    v_mfma_f32_16x16x32_bf16 v[228:231], v[108:111], v[52:55], v[228:231]
    s_nop 0
    v_add_f32_dpp v245, v243, v236 wave_shr:1 row_mask:0xf bank_mask:0xf
    v_mfma_f32_16x16x32_bf16 v[228:231], v[100:103], v[56:59], v[228:231]
    v_cvt_pk_bf16_f32 v13, v244, v245
    v_mfma_f32_16x16x32_bf16 v[232:235], v[152:155], v[32:35], 0
    v_add_f32_dpp v240, v239, v226 wave_ror:1 row_mask:0xf bank_mask:0xf
    v_add_f32_dpp v242, v241, v225 wave_ror:1 row_mask:0xf bank_mask:0xf
    v_mfma_f32_16x16x32_bf16 v[232:235], v[144:147], v[36:39], v[232:235]
    v_add_f32_dpp v244, v243, v224 wave_ror:1 row_mask:0xf bank_mask:0xf
    v_add_f32_dpp v240, v227, v226 wave_shr:1 row_mask:0xf bank_mask:0xf
    v_mfma_f32_16x16x32_bf16 v[232:235], v[136:139], v[40:43], v[232:235]
    v_mfma_f32_16x16x32_bf16 v[232:235], v[128:131], v[44:47], v[232:235]
    v_add_f32_dpp v242, v240, v225 wave_shr:1 row_mask:0xf bank_mask:0xf
    v_mfma_f32_16x16x32_bf16 v[232:235], v[120:123], v[48:51], v[232:235]
    v_mfma_f32_16x16x32_bf16 v[232:235], v[112:115], v[52:55], v[232:235]
    v_add_f32_dpp v244, v242, v224 wave_shr:1 row_mask:0xf bank_mask:0xf
    v_mfma_f32_16x16x32_bf16 v[232:235], v[104:107], v[56:59], v[232:235]
    v_mfma_f32_16x16x32_bf16 v[232:235], v[96:99], v[60:63], v[232:235]
    v_mfma_f32_16x16x32_bf16 v[236:239], v[156:159], v[32:35], 0
    v_add_f32_dpp v241, v227, v230 wave_ror:1 row_mask:0xf bank_mask:0xf
    v_add_f32_dpp v243, v240, v229 wave_ror:1 row_mask:0xf bank_mask:0xf
    v_mfma_f32_16x16x32_bf16 v[236:239], v[148:151], v[36:39], v[236:239]
    v_add_f32_dpp v245, v242, v228 wave_ror:1 row_mask:0xf bank_mask:0xf
    v_add_f32_dpp v241, v231, v230 wave_shr:1 row_mask:0xf bank_mask:0xf
    v_mfma_f32_16x16x32_bf16 v[236:239], v[140:143], v[40:43], v[236:239]
L_hop9:
    s_cbranch_execz L_hopback
    v_mfma_f32_16x16x32_bf16 v[236:239], v[132:135], v[44:47], v[236:239]
    v_add_f32_dpp v243, v241, v229 wave_shr:1 row_mask:0xf bank_mask:0xf
    v_mfma_f32_16x16x32_bf16 v[236:239], v[124:127], v[48:51], v[236:239]
    v_mfma_f32_16x16x32_bf16 v[236:239], v[116:119], v[52:55], v[236:239]
    v_add_f32_dpp v245, v243, v228 wave_shr:1 row_mask:0xf bank_mask:0xf
    v_mfma_f32_16x16x32_bf16 v[236:239], v[108:111], v[56:59], v[236:239]
    v_cvt_pk_bf16_f32 v14, v244, v245
    v_mfma_f32_16x16x32_bf16 v[236:239], v[100:103], v[60:63], v[236:239]
    v_mfma_f32_16x16x32_bf16 v[224:227], v[160:163], v[32:35], 0
    v_add_f32_dpp v240, v231, v234 wave_ror:1 row_mask:0xf bank_mask:0xf
    v_add_f32_dpp v242, v241, v233 wave_ror:1 row_mask:0xf bank_mask:0xf
    v_mfma_f32_16x16x32_bf16 v[224:227], v[152:155], v[36:39], v[224:227]
    v_add_f32_dpp v244, v243, v232 wave_ror:1 row_mask:0xf bank_mask:0xf
    v_add_f32_dpp v240, v235, v234 wave_shr:1 row_mask:0xf bank_mask:0xf
    v_mfma_f32_16x16x32_bf16 v[224:227], v[144:147], v[40:43], v[224:227]
    v_mfma_f32_16x16x32_bf16 v[224:227], v[136:139], v[44:47], v[224:227]
    v_add_f32_dpp v242, v240, v233 wave_shr:1 row_mask:0xf bank_mask:0xf
    v_mfma_f32_16x16x32_bf16 v[224:227], v[128:131], v[48:51], v[224:227]
    v_mfma_f32_16x16x32_bf16 v[224:227], v[120:123], v[52:55], v[224:227]
    v_add_f32_dpp v244, v242, v232 wave_shr:1 row_mask:0xf bank_mask:0xf
    v_mfma_f32_16x16x32_bf16 v[224:227], v[112:115], v[56:59], v[224:227]
    v_mfma_f32_16x16x32_bf16 v[224:227], v[104:107], v[60:63], v[224:227]
    v_mfma_f32_16x16x32_bf16 v[224:227], v[96:99], v[64:67], v[224:227]
    v_mfma_f32_16x16x32_bf16 v[228:231], v[164:167], v[32:35], 0
    v_add_f32_dpp v241, v235, v238 wave_ror:1 row_mask:0xf bank_mask:0xf
    v_add_f32_dpp v243, v240, v237 wave_ror:1 row_mask:0xf bank_mask:0xf
    v_mfma_f32_16x16x32_bf16 v[228:231], v[156:159], v[36:39], v[228:231]
    v_add_f32_dpp v245, v242, v236 wave_ror:1 row_mask:0xf bank_mask:0xf
    v_add_f32_dpp v241, v239, v238 wave_shr:1 row_mask:0xf bank_mask:0xf
    v_mfma_f32_16x16x32_bf16 v[228:231], v[148:151], v[40:43], v[228:231]
    v_mfma_f32_16x16x32_bf16 v[228:231], v[140:143], v[44:47], v[228:231]
    v_add_f32_dpp v243, v241, v237 wave_shr:1 row_mask:0xf bank_mask:0xf
    v_mfma_f32_16x16x32_bf16 v[228:231], v[132:135], v[48:51], v[228:231]
    v_mfma_f32_16x16x32_bf16 v[228:231], v[124:127], v[52:55], v[228:231]
    v_add_f32_dpp v245, v243, v236 wave_shr:1 row_mask:0xf bank_mask:0xf
    v_mfma_f32_16x16x32_bf16 v[228:231], v[116:119], v[56:59], v[228:231]
    v_cvt_pk_bf16_f32 v15, v244, v245
    v_mfma_f32_16x16x32_bf16 v[228:231], v[108:111], v[60:63], v[228:231]
    v_mfma_f32_16x16x32_bf16 v[228:231], v[100:103], v[64:67], v[228:231]
    v_mfma_f32_16x16x32_bf16 v[232:235], v[168:171], v[32:35], 0
    v_add_f32_dpp v240, v239, v226 wave_ror:1 row_mask:0xf bank_mask:0xf
    v_add_f32_dpp v242, v241, v225 wave_ror:1 row_mask:0xf bank_mask:0xf
    v_mfma_f32_16x16x32_bf16 v[232:235], v[160:163], v[36:39], v[232:235]
    v_add_f32_dpp v244, v243, v224 wave_ror:1 row_mask:0xf bank_mask:0xf
    v_add_f32_dpp v240, v227, v226 wave_shr:1 row_mask:0xf bank_mask:0xf
    v_mfma_f32_16x16x32_bf16 v[232:235], v[152:155], v[40:43], v[232:235]
    v_mfma_f32_16x16x32_bf16 v[232:235], v[144:147], v[44:47], v[232:235]
    v_add_f32_dpp v242, v240, v225 wave_shr:1 row_mask:0xf bank_mask:0xf
    v_mfma_f32_16x16x32_bf16 v[232:235], v[136:139], v[48:51], v[232:235]
    v_mfma_f32_16x16x32_bf16 v[232:235], v[128:131], v[52:55], v[232:235]
    v_add_f32_dpp v244, v242, v224 wave_shr:1 row_mask:0xf bank_mask:0xf
    v_mfma_f32_16x16x32_bf16 v[232:235], v[120:123], v[56:59], v[232:235]
    v_mfma_f32_16x16x32_bf16 v[232:235], v[112:115], v[60:63], v[232:235]
    v_mfma_f32_16x16x32_bf16 v[232:235], v[104:107], v[64:67], v[232:235]
    v_mfma_f32_16x16x32_bf16 v[232:235], v[96:99], v[68:71], v[232:235]
    v_mfma_f32_16x16x32_bf16 v[236:239], v[172:175], v[32:35], 0
    v_add_f32_dpp v241, v227, v230 wave_ror:1 row_mask:0xf bank_mask:0xf
    v_add_f32_dpp v243, v240, v229 wave_ror:1 row_mask:0xf bank_mask:0xf
    v_mfma_f32_16x16x32_bf16 v[236:239], v[164:167], v[36:39], v[236:239]
    v_add_f32_dpp v245, v242, v228 wave_ror:1 row_mask:0xf bank_mask:0xf
    v_add_f32_dpp v241, v231, v230 wave_shr:1 row_mask:0xf bank_mask:0xf
    v_mfma_f32_16x16x32_bf16 v[236:239], v[156:159], v[40:43], v[236:239]
    v_mfma_f32_16x16x32_bf16 v[236:239], v[148:151], v[44:47], v[236:239]
    v_add_f32_dpp v243, v241, v229 wave_shr:1 row_mask:0xf bank_mask:0xf
    v_mfma_f32_16x16x32_bf16 v[236:239], v[140:143], v[48:51], v[236:239]
    v_mfma_f32_16x16x32_bf16 v[236:239], v[132:135], v[52:55], v[236:239]
    v_add_f32_dpp v245, v243, v228 wave_shr:1 row_mask:0xf bank_mask:0xf
    v_mfma_f32_16x16x32_bf16 v[236:239], v[124:127], v[56:59], v[236:239]
    v_cvt_pk_bf16_f32 v16, v244, v245
    v_mfma_f32_16x16x32_bf16 v[236:239], v[116:119], v[60:63], v[236:239]
    v_mfma_f32_16x16x32_bf16 v[236:239], v[108:111], v[64:67], v[236:239]
    v_mfma_f32_16x16x32_bf16 v[236:239], v[100:103], v[68:71], v[236:239]
    v_mfma_f32_16x16x32_bf16 v[224:227], v[176:179], v[32:35], 0
    v_add_f32_dpp v240, v231, v234 wave_ror:1 row_mask:0xf bank_mask:0xf
    v_add_f32_dpp v242, v241, v233 wave_ror:1 row_mask:0xf bank_mask:0xf
    v_mfma_f32_16x16x32_bf16 v[224:227], v[168:171], v[36:39], v[224:227]
    v_add_f32_dpp v244, v243, v232 wave_ror:1 row_mask:0xf bank_mask:0xf
    v_add_f32_dpp v240, v235, v234 wave_shr:1 row_mask:0xf bank_mask:0xf
    v_mfma_f32_16x16x32_bf16 v[224:227], v[160:163], v[40:43], v[224:227]
    v_mfma_f32_16x16x32_bf16 v[224:227], v[152:155], v[44:47], v[224:227]
    v_add_f32_dpp v242, v240, v233 wave_shr:1 row_mask:0xf bank_mask:0xf
    v_mfma_f32_16x16x32_bf16 v[224:227], v[144:147], v[48:51], v[224:227]
    v_mfma_f32_16x16x32_bf16 v[224:227], v[136:139], v[52:55], v[224:227]
    v_add_f32_dpp v244, v242, v232 wave_shr:1 row_mask:0xf bank_mask:0xf
    v_mfma_f32_16x16x32_bf16 v[224:227], v[128:131], v[56:59], v[224:227]
    v_mfma_f32_16x16x32_bf16 v[224:227], v[120:123], v[60:63], v[224:227]
    v_mfma_f32_16x16x32_bf16 v[224:227], v[112:115], v[64:67], v[224:227]
    v_mfma_f32_16x16x32_bf16 v[224:227], v[104:107], v[68:71], v[224:227]
    v_mfma_f32_16x16x32_bf16 v[224:227], v[96:99], v[72:75], v[224:227]
    v_mfma_f32_16x16x32_bf16 v[228:231], v[180:183], v[32:35], 0
    v_add_f32_dpp v241, v235, v238 wave_ror:1 row_mask:0xf bank_mask:0xf
    v_add_f32_dpp v243, v240, v237 wave_ror:1 row_mask:0xf bank_mask:0xf
    v_mfma_f32_16x16x32_bf16 v[228:231], v[172:175], v[36:39], v[228:231]
    v_add_f32_dpp v245, v242, v236 wave_ror:1 row_mask:0xf bank_mask:0xf
    v_add_f32_dpp v241, v239, v238 wave_shr:1 row_mask:0xf bank_mask:0xf
    v_mfma_f32_16x16x32_bf16 v[228:231], v[164:167], v[40:43], v[228:231]
    v_mfma_f32_16x16x32_bf16 v[228:231], v[156:159], v[44:47], v[228:231]
    v_add_f32_dpp v243, v241, v237 wave_shr:1 row_mask:0xf bank_mask:0xf
    v_mfma_f32_16x16x32_bf16 v[228:231], v[148:151], v[48:51], v[228:231]
    v_mfma_f32_16x16x32_bf16 v[228:231], v[140:143], v[52:55], v[228:231]
    v_add_f32_dpp v245, v243, v236 wave_shr:1 row_mask:0xf bank_mask:0xf
    v_mfma_f32_16x16x32_bf16 v[228:231], v[132:135], v[56:59], v[228:231]
    v_cvt_pk_bf16_f32 v17, v244, v245
    v_mfma_f32_16x16x32_bf16 v[228:231], v[124:127], v[60:63], v[228:231]
    v_mfma_f32_16x16x32_bf16 v[228:231], v[116:119], v[64:67], v[228:231]
    v_mfma_f32_16x16x32_bf16 v[228:231], v[108:111], v[68:71], v[228:231]
    v_mfma_f32_16x16x32_bf16 v[228:231], v[100:103], v[72:75], v[228:231]
    v_mfma_f32_16x16x32_bf16 v[232:235], v[184:187], v[32:35], 0
    v_add_f32_dpp v240, v239, v226 wave_ror:1 row_mask:0xf bank_mask:0xf
    v_add_f32_dpp v242, v241, v225 wave_ror:1 row_mask:0xf bank_mask:0xf
    v_mfma_f32_16x16x32_bf16 v[232:235], v[176:179], v[36:39], v[232:235]
    v_add_f32_dpp v244, v243, v224 wave_ror:1 row_mask:0xf bank_mask:0xf
    v_add_f32_dpp v240, v227, v226 wave_shr:1 row_mask:0xf bank_mask:0xf
    v_mfma_f32_16x16x32_bf16 v[232:235], v[168:171], v[40:43], v[232:235]
    v_mfma_f32_16x16x32_bf16 v[232:235], v[160:163], v[44:47], v[232:235]
    v_add_f32_dpp v242, v240, v225 wave_shr:1 row_mask:0xf bank_mask:0xf
    v_mfma_f32_16x16x32_bf16 v[232:235], v[152:155], v[48:51], v[232:235]
    v_mfma_f32_16x16x32_bf16 v[232:235], v[144:147], v[52:55], v[232:235]
    v_add_f32_dpp v244, v242, v224 wave_shr:1 row_mask:0xf bank_mask:0xf
    v_mfma_f32_16x16x32_bf16 v[232:235], v[136:139], v[56:59], v[232:235]
    v_mfma_f32_16x16x32_bf16 v[232:235], v[128:131], v[60:63], v[232:235]
    v_mfma_f32_16x16x32_bf16 v[232:235], v[120:123], v[64:67], v[232:235]
    v_mfma_f32_16x16x32_bf16 v[232:235], v[112:115], v[68:71], v[232:235]
    v_mfma_f32_16x16x32_bf16 v[232:235], v[104:107], v[72:75], v[232:235]
    v_mfma_f32_16x16x32_bf16 v[232:235], v[96:99], v[76:79], v[232:235]
    v_mfma_f32_16x16x32_bf16 v[236:239], v[188:191], v[32:35], 0
    v_add_f32_dpp v241, v227, v230 wave_ror:1 row_mask:0xf bank_mask:0xf
    v_add_f32_dpp v243, v240, v229 wave_ror:1 row_mask:0xf bank_mask:0xf
L_hop10:
    s_cbranch_execz L_hopback
    v_mfma_f32_16x16x32_bf16 v[236:239], v[180:183], v[36:39], v[236:239]
    v_add_f32_dpp v245, v242, v228 wave_ror:1 row_mask:0xf bank_mask:0xf
    v_add_f32_dpp v241, v231, v230 wave_shr:1 row_mask:0xf bank_mask:0xf
    v_mfma_f32_16x16x32_bf16 v[236:239], v[172:175], v[40:43], v[236:239]
    v_mfma_f32_16x16x32_bf16 v[236:239], v[164:167], v[44:47], v[236:239]
    v_add_f32_dpp v243, v241, v229 wave_shr:1 row_mask:0xf bank_mask:0xf
    v_mfma_f32_16x16x32_bf16 v[236:239], v[156:159], v[48:51], v[236:239]
    v_mfma_f32_16x16x32_bf16 v[236:239], v[148:151], v[52:55], v[236:239]
    v_add_f32_dpp v245, v243, v228 wave_shr:1 row_mask:0xf bank_mask:0xf
    v_mfma_f32_16x16x32_bf16 v[236:239], v[140:143], v[56:59], v[236:239]
    v_cvt_pk_bf16_f32 v18, v244, v245
    v_mfma_f32_16x16x32_bf16 v[236:239], v[132:135], v[60:63], v[236:239]
    v_mfma_f32_16x16x32_bf16 v[236:239], v[124:127], v[64:67], v[236:239]
    v_mfma_f32_16x16x32_bf16 v[236:239], v[116:119], v[68:71], v[236:239]
    v_mfma_f32_16x16x32_bf16 v[236:239], v[108:111], v[72:75], v[236:239]
    v_mfma_f32_16x16x32_bf16 v[236:239], v[100:103], v[76:79], v[236:239]
    v_mfma_f32_16x16x32_bf16 v[224:227], v[192:195], v[32:35], 0
    v_add_f32_dpp v240, v231, v234 wave_ror:1 row_mask:0xf bank_mask:0xf
    v_add_f32_dpp v242, v241, v233 wave_ror:1 row_mask:0xf bank_mask:0xf
    v_mfma_f32_16x16x32_bf16 v[224:227], v[184:187], v[36:39], v[224:227]
    v_add_f32_dpp v244, v243, v232 wave_ror:1 row_mask:0xf bank_mask:0xf
    v_add_f32_dpp v240, v235, v234 wave_shr:1 row_mask:0xf bank_mask:0xf
    v_mfma_f32_16x16x32_bf16 v[224:227], v[176:179], v[40:43], v[224:227]
    v_mfma_f32_16x16x32_bf16 v[224:227], v[168:171], v[44:47], v[224:227]
    v_add_f32_dpp v242, v240, v233 wave_shr:1 row_mask:0xf bank_mask:0xf
    v_mfma_f32_16x16x32_bf16 v[224:227], v[160:163], v[48:51], v[224:227]
    v_mfma_f32_16x16x32_bf16 v[224:227], v[152:155], v[52:55], v[224:227]
    v_add_f32_dpp v244, v242, v232 wave_shr:1 row_mask:0xf bank_mask:0xf
    v_mfma_f32_16x16x32_bf16 v[224:227], v[144:147], v[56:59], v[224:227]
    v_mfma_f32_16x16x32_bf16 v[224:227], v[136:139], v[60:63], v[224:227]
    v_mfma_f32_16x16x32_bf16 v[224:227], v[128:131], v[64:67], v[224:227]
    v_mfma_f32_16x16x32_bf16 v[224:227], v[120:123], v[68:71], v[224:227]
    v_mfma_f32_16x16x32_bf16 v[224:227], v[112:115], v[72:75], v[224:227]
    v_mfma_f32_16x16x32_bf16 v[224:227], v[104:107], v[76:79], v[224:227]
    v_mfma_f32_16x16x32_bf16 v[224:227], v[96:99], v[80:83], v[224:227]
    v_mfma_f32_16x16x32_bf16 v[228:231], v[196:199], v[32:35], 0
    v_add_f32_dpp v241, v235, v238 wave_ror:1 row_mask:0xf bank_mask:0xf
    v_add_f32_dpp v243, v240, v237 wave_ror:1 row_mask:0xf bank_mask:0xf
    v_mfma_f32_16x16x32_bf16 v[228:231], v[188:191], v[36:39], v[228:231]
    v_add_f32_dpp v245, v242, v236 wave_ror:1 row_mask:0xf bank_mask:0xf
    v_add_f32_dpp v241, v239, v238 wave_shr:1 row_mask:0xf bank_mask:0xf
    v_mfma_f32_16x16x32_bf16 v[228:231], v[180:183], v[40:43], v[228:231]
    v_mfma_f32_16x16x32_bf16 v[228:231], v[172:175], v[44:47], v[228:231]
    v_add_f32_dpp v243, v241, v237 wave_shr:1 row_mask:0xf bank_mask:0xf
    v_mfma_f32_16x16x32_bf16 v[228:231], v[164:167], v[48:51], v[228:231]
    v_mfma_f32_16x16x32_bf16 v[228:231], v[156:159], v[52:55], v[228:231]
    v_add_f32_dpp v245, v243, v236 wave_shr:1 row_mask:0xf bank_mask:0xf
    v_mfma_f32_16x16x32_bf16 v[228:231], v[148:151], v[56:59], v[228:231]
    v_cvt_pk_bf16_f32 v19, v244, v245
    v_mfma_f32_16x16x32_bf16 v[228:231], v[140:143], v[60:63], v[228:231]
    v_mfma_f32_16x16x32_bf16 v[228:231], v[132:135], v[64:67], v[228:231]
    v_mfma_f32_16x16x32_bf16 v[228:231], v[124:127], v[68:71], v[228:231]
    v_mfma_f32_16x16x32_bf16 v[228:231], v[116:119], v[72:75], v[228:231]
    v_mfma_f32_16x16x32_bf16 v[228:231], v[108:111], v[76:79], v[228:231]
    v_mfma_f32_16x16x32_bf16 v[228:231], v[100:103], v[80:83], v[228:231]
    v_mfma_f32_16x16x32_bf16 v[232:235], v[200:203], v[32:35], 0
    v_add_f32_dpp v240, v239, v226 wave_ror:1 row_mask:0xf bank_mask:0xf
    v_add_f32_dpp v242, v241, v225 wave_ror:1 row_mask:0xf bank_mask:0xf
    v_mfma_f32_16x16x32_bf16 v[232:235], v[192:195], v[36:39], v[232:235]
    v_add_f32_dpp v244, v243, v224 wave_ror:1 row_mask:0xf bank_mask:0xf
    v_add_f32_dpp v240, v227, v226 wave_shr:1 row_mask:0xf bank_mask:0xf
    v_mfma_f32_16x16x32_bf16 v[232:235], v[184:187], v[40:43], v[232:235]
    v_mfma_f32_16x16x32_bf16 v[232:235], v[176:179], v[44:47], v[232:235]
    v_add_f32_dpp v242, v240, v225 wave_shr:1 row_mask:0xf bank_mask:0xf
    v_mfma_f32_16x16x32_bf16 v[232:235], v[168:171], v[48:51], v[232:235]
    v_mfma_f32_16x16x32_bf16 v[232:235], v[160:163], v[52:55], v[232:235]
    v_add_f32_dpp v244, v242, v224 wave_shr:1 row_mask:0xf bank_mask:0xf
    v_mfma_f32_16x16x32_bf16 v[232:235], v[152:155], v[56:59], v[232:235]
    v_mfma_f32_16x16x32_bf16 v[232:235], v[144:147], v[60:63], v[232:235]
    v_mfma_f32_16x16x32_bf16 v[232:235], v[136:139], v[64:67], v[232:235]
    v_mfma_f32_16x16x32_bf16 v[232:235], v[128:131], v[68:71], v[232:235]
    v_mfma_f32_16x16x32_bf16 v[232:235], v[120:123], v[72:75], v[232:235]
    v_mfma_f32_16x16x32_bf16 v[232:235], v[112:115], v[76:79], v[232:235]
    v_mfma_f32_16x16x32_bf16 v[232:235], v[104:107], v[80:83], v[232:235]
    v_mfma_f32_16x16x32_bf16 v[232:235], v[96:99], v[84:87], v[232:235]
    v_mfma_f32_16x16x32_bf16 v[236:239], v[204:207], v[32:35], 0
    v_add_f32_dpp v241, v227, v230 wave_ror:1 row_mask:0xf bank_mask:0xf
    v_add_f32_dpp v243, v240, v229 wave_ror:1 row_mask:0xf bank_mask:0xf
    v_mfma_f32_16x16x32_bf16 v[236:239], v[196:199], v[36:39], v[236:239]
    v_add_f32_dpp v245, v242, v228 wave_ror:1 row_mask:0xf bank_mask:0xf
    v_add_f32_dpp v241, v231, v230 wave_shr:1 row_mask:0xf bank_mask:0xf
    v_mfma_f32_16x16x32_bf16 v[236:239], v[188:191], v[40:43], v[236:239]
    v_mfma_f32_16x16x32_bf16 v[236:239], v[180:183], v[44:47], v[236:239]
    v_add_f32_dpp v243, v241, v229 wave_shr:1 row_mask:0xf bank_mask:0xf
    v_mfma_f32_16x16x32_bf16 v[236:239], v[172:175], v[48:51], v[236:239]
    v_mfma_f32_16x16x32_bf16 v[236:239], v[164:167], v[52:55], v[236:239]
    v_add_f32_dpp v245, v243, v228 wave_shr:1 row_mask:0xf bank_mask:0xf
    v_mfma_f32_16x16x32_bf16 v[236:239], v[156:159], v[56:59], v[236:239]
    v_cvt_pk_bf16_f32 v20, v244, v245
    v_mfma_f32_16x16x32_bf16 v[236:239], v[148:151], v[60:63], v[236:239]
    v_mfma_f32_16x16x32_bf16 v[236:239], v[140:143], v[64:67], v[236:239]
    v_mfma_f32_16x16x32_bf16 v[236:239], v[132:135], v[68:71], v[236:239]
    v_mfma_f32_16x16x32_bf16 v[236:239], v[124:127], v[72:75], v[236:239]
    v_mfma_f32_16x16x32_bf16 v[236:239], v[116:119], v[76:79], v[236:239]
    v_mfma_f32_16x16x32_bf16 v[236:239], v[108:111], v[80:83], v[236:239]
    v_mfma_f32_16x16x32_bf16 v[236:239], v[100:103], v[84:87], v[236:239]
    v_mfma_f32_16x16x32_bf16 v[224:227], v[208:211], v[32:35], 0
    v_add_f32_dpp v240, v231, v234 wave_ror:1 row_mask:0xf bank_mask:0xf
    v_add_f32_dpp v242, v241, v233 wave_ror:1 row_mask:0xf bank_mask:0xf
    v_mfma_f32_16x16x32_bf16 v[224:227], v[200:203], v[36:39], v[224:227]
    v_add_f32_dpp v244, v243, v232 wave_ror:1 row_mask:0xf bank_mask:0xf
    v_add_f32_dpp v240, v235, v234 wave_shr:1 row_mask:0xf bank_mask:0xf
    v_mfma_f32_16x16x32_bf16 v[224:227], v[192:195], v[40:43], v[224:227]
    v_mfma_f32_16x16x32_bf16 v[224:227], v[184:187], v[44:47], v[224:227]
    v_add_f32_dpp v242, v240, v233 wave_shr:1 row_mask:0xf bank_mask:0xf
    v_mfma_f32_16x16x32_bf16 v[224:227], v[176:179], v[48:51], v[224:227]
    v_mfma_f32_16x16x32_bf16 v[224:227], v[168:171], v[52:55], v[224:227]
    v_add_f32_dpp v244, v242, v232 wave_shr:1 row_mask:0xf bank_mask:0xf
    v_mfma_f32_16x16x32_bf16 v[224:227], v[160:163], v[56:59], v[224:227]
    v_mfma_f32_16x16x32_bf16 v[224:227], v[152:155], v[60:63], v[224:227]
    v_mfma_f32_16x16x32_bf16 v[224:227], v[144:147], v[64:67], v[224:227]
    v_mfma_f32_16x16x32_bf16 v[224:227], v[136:139], v[68:71], v[224:227]
    v_mfma_f32_16x16x32_bf16 v[224:227], v[128:131], v[72:75], v[224:227]
    v_mfma_f32_16x16x32_bf16 v[224:227], v[120:123], v[76:79], v[224:227]
    v_mfma_f32_16x16x32_bf16 v[224:227], v[112:115], v[80:83], v[224:227]
    v_mfma_f32_16x16x32_bf16 v[224:227], v[104:107], v[84:87], v[224:227]
    v_mfma_f32_16x16x32_bf16 v[224:227], v[96:99], v[88:91], v[224:227]
    v_mfma_f32_16x16x32_bf16 v[228:231], v[212:215], v[32:35], 0
    v_add_f32_dpp v241, v235, v238 wave_ror:1 row_mask:0xf bank_mask:0xf
    v_add_f32_dpp v243, v240, v237 wave_ror:1 row_mask:0xf bank_mask:0xf
    v_mfma_f32_16x16x32_bf16 v[228:231], v[204:207], v[36:39], v[228:231]
    v_add_f32_dpp v245, v242, v236 wave_ror:1 row_mask:0xf bank_mask:0xf
    v_add_f32_dpp v241, v239, v238 wave_shr:1 row_mask:0xf bank_mask:0xf
    v_mfma_f32_16x16x32_bf16 v[228:231], v[196:199], v[40:43], v[228:231]
    v_mfma_f32_16x16x32_bf16 v[228:231], v[188:191], v[44:47], v[228:231]
    v_add_f32_dpp v243, v241, v237 wave_shr:1 row_mask:0xf bank_mask:0xf
    v_mfma_f32_16x16x32_bf16 v[228:231], v[180:183], v[48:51], v[228:231]
L_hop11:
    s_cbranch_execz L_hopback
    v_mfma_f32_16x16x32_bf16 v[228:231], v[172:175], v[52:55], v[228:231]
    v_add_f32_dpp v245, v243, v236 wave_shr:1 row_mask:0xf bank_mask:0xf
    v_mfma_f32_16x16x32_bf16 v[228:231], v[164:167], v[56:59], v[228:231]
    v_cvt_pk_bf16_f32 v21, v244, v245
    v_mfma_f32_16x16x32_bf16 v[228:231], v[156:159], v[60:63], v[228:231]
    v_mfma_f32_16x16x32_bf16 v[228:231], v[148:151], v[64:67], v[228:231]
    v_mfma_f32_16x16x32_bf16 v[228:231], v[140:143], v[68:71], v[228:231]
    v_mfma_f32_16x16x32_bf16 v[228:231], v[132:135], v[72:75], v[228:231]
    v_mfma_f32_16x16x32_bf16 v[228:231], v[124:127], v[76:79], v[228:231]
    v_mfma_f32_16x16x32_bf16 v[228:231], v[116:119], v[80:83], v[228:231]
    v_mfma_f32_16x16x32_bf16 v[228:231], v[108:111], v[84:87], v[228:231]
    v_mfma_f32_16x16x32_bf16 v[228:231], v[100:103], v[88:91], v[228:231]
    v_mfma_f32_16x16x32_bf16 v[232:235], v[216:219], v[32:35], 0
    v_add_f32_dpp v240, v239, v226 wave_ror:1 row_mask:0xf bank_mask:0xf
    v_add_f32_dpp v242, v241, v225 wave_ror:1 row_mask:0xf bank_mask:0xf
    v_mfma_f32_16x16x32_bf16 v[232:235], v[208:211], v[36:39], v[232:235]
    v_add_f32_dpp v244, v243, v224 wave_ror:1 row_mask:0xf bank_mask:0xf
    v_add_f32_dpp v240, v227, v226 wave_shr:1 row_mask:0xf bank_mask:0xf
    v_mfma_f32_16x16x32_bf16 v[232:235], v[200:203], v[40:43], v[232:235]
    v_mfma_f32_16x16x32_bf16 v[232:235], v[192:195], v[44:47], v[232:235]
    v_add_f32_dpp v242, v240, v225 wave_shr:1 row_mask:0xf bank_mask:0xf
    v_mfma_f32_16x16x32_bf16 v[232:235], v[184:187], v[48:51], v[232:235]
    v_mfma_f32_16x16x32_bf16 v[232:235], v[176:179], v[52:55], v[232:235]
    v_add_f32_dpp v244, v242, v224 wave_shr:1 row_mask:0xf bank_mask:0xf
    v_mfma_f32_16x16x32_bf16 v[232:235], v[168:171], v[56:59], v[232:235]
    v_mfma_f32_16x16x32_bf16 v[232:235], v[160:163], v[60:63], v[232:235]
    v_mfma_f32_16x16x32_bf16 v[232:235], v[152:155], v[64:67], v[232:235]
    v_mfma_f32_16x16x32_bf16 v[232:235], v[144:147], v[68:71], v[232:235]
    v_mfma_f32_16x16x32_bf16 v[232:235], v[136:139], v[72:75], v[232:235]
    v_mfma_f32_16x16x32_bf16 v[232:235], v[128:131], v[76:79], v[232:235]
    v_mfma_f32_16x16x32_bf16 v[232:235], v[120:123], v[80:83], v[232:235]
    v_mfma_f32_16x16x32_bf16 v[232:235], v[112:115], v[84:87], v[232:235]
    v_mfma_f32_16x16x32_bf16 v[232:235], v[104:107], v[88:91], v[232:235]
    v_mfma_f32_16x16x32_bf16 v[232:235], v[96:99], v[92:95], v[232:235]
    v_mfma_f32_16x16x32_bf16 v[236:239], v[220:223], v[32:35], 0
    v_add_f32_dpp v241, v227, v230 wave_ror:1 row_mask:0xf bank_mask:0xf
    v_add_f32_dpp v243, v240, v229 wave_ror:1 row_mask:0xf bank_mask:0xf
    v_mfma_f32_16x16x32_bf16 v[236:239], v[212:215], v[36:39], v[236:239]
    v_add_f32_dpp v245, v242, v228 wave_ror:1 row_mask:0xf bank_mask:0xf
    v_add_f32_dpp v241, v231, v230 wave_shr:1 row_mask:0xf bank_mask:0xf
    v_mfma_f32_16x16x32_bf16 v[236:239], v[204:207], v[40:43], v[236:239]
    v_mfma_f32_16x16x32_bf16 v[236:239], v[196:199], v[44:47], v[236:239]
    v_add_f32_dpp v243, v241, v229 wave_shr:1 row_mask:0xf bank_mask:0xf
    v_mfma_f32_16x16x32_bf16 v[236:239], v[188:191], v[48:51], v[236:239]
    v_mfma_f32_16x16x32_bf16 v[236:239], v[180:183], v[52:55], v[236:239]
    v_add_f32_dpp v245, v243, v228 wave_shr:1 row_mask:0xf bank_mask:0xf
    v_mfma_f32_16x16x32_bf16 v[236:239], v[172:175], v[56:59], v[236:239]
    v_cvt_pk_bf16_f32 v22, v244, v245
    v_mfma_f32_16x16x32_bf16 v[236:239], v[164:167], v[60:63], v[236:239]
    v_mfma_f32_16x16x32_bf16 v[236:239], v[156:159], v[64:67], v[236:239]
    v_mfma_f32_16x16x32_bf16 v[236:239], v[148:151], v[68:71], v[236:239]
    v_mfma_f32_16x16x32_bf16 v[236:239], v[140:143], v[72:75], v[236:239]
    v_mfma_f32_16x16x32_bf16 v[236:239], v[132:135], v[76:79], v[236:239]
    v_mfma_f32_16x16x32_bf16 v[236:239], v[124:127], v[80:83], v[236:239]
    v_mfma_f32_16x16x32_bf16 v[236:239], v[116:119], v[84:87], v[236:239]
    v_mfma_f32_16x16x32_bf16 v[236:239], v[108:111], v[88:91], v[236:239]
    v_mfma_f32_16x16x32_bf16 v[236:239], v[100:103], v[92:95], v[236:239]
    v_add_f32_dpp v240, v231, v234 wave_ror:1 row_mask:0xf bank_mask:0xf
    v_add_f32_dpp v242, v241, v233 wave_ror:1 row_mask:0xf bank_mask:0xf
    v_add_f32_dpp v244, v243, v232 wave_ror:1 row_mask:0xf bank_mask:0xf
    v_add_f32_dpp v240, v235, v234 wave_shr:1 row_mask:0xf bank_mask:0xf
    s_nop 1
    v_add_f32_dpp v242, v240, v233 wave_shr:1 row_mask:0xf bank_mask:0xf
    s_nop 1
    v_add_f32_dpp v244, v242, v232 wave_shr:1 row_mask:0xf bank_mask:0xf
    v_add_f32_dpp v241, v235, v238 wave_ror:1 row_mask:0xf bank_mask:0xf
    v_add_f32_dpp v243, v240, v237 wave_ror:1 row_mask:0xf bank_mask:0xf
    v_add_f32_dpp v245, v242, v236 wave_ror:1 row_mask:0xf bank_mask:0xf
    v_add_f32_dpp v241, v239, v238 wave_shr:1 row_mask:0xf bank_mask:0xf
    s_nop 1
    v_add_f32_dpp v243, v241, v237 wave_shr:1 row_mask:0xf bank_mask:0xf
    s_nop 1
    v_add_f32_dpp v245, v243, v236 wave_shr:1 row_mask:0xf bank_mask:0xf
    v_cvt_pk_bf16_f32 v23, v244, v245
    s_setprio 3
    v_mov_b32 v4, 163604
    s_mov_b32 s16, 200000
L_lw18:
    ds_read_b32 v5, v4
    s_sub_u32 s16, s16, 1
    s_cbranch_scc1 L_ld19
    s_waitcnt lgkmcnt(0)
    v_cmp_gt_u32 vcc, 4, v5
    s_cbranch_vccnz L_lw18
L_ld19:
    s_lshr_b32 s47, s40, 1
    s_mul_i32 s47, s47, 40960
    s_and_b32 s48, s40, 1
    s_lshl_b32 s48, s48, 12
    s_add_u32 s47, s47, s48
    s_add_u32 s47, s47, 67584
    v_lshl_add_u32 v3, v2, 2, s47
    ds_write2st64_b32 v3, v8, v9 offset0:0 offset1:1
    ds_write2st64_b32 v3, v10, v11 offset0:2 offset1:3
    ds_write2st64_b32 v3, v12, v13 offset0:4 offset1:5
    ds_write2st64_b32 v3, v14, v15 offset0:6 offset1:7
    ds_write2st64_b32 v3, v16, v17 offset0:8 offset1:9
    ds_write2st64_b32 v3, v18, v19 offset0:10 offset1:11
    ds_write2st64_b32 v3, v20, v21 offset0:12 offset1:13
    ds_write2st64_b32 v3, v22, v23 offset0:14 offset1:15
    v_mov_b32 v4, 163600
    v_mov_b32 v5, 1
    s_mov_b64 exec, 1
    ds_add_u32 v4, v5
    s_mov_b64 exec, -1
    v_mov_b32 v3, 163600
    s_mov_b32 s16, 200000
L_lw20:
    ds_read_b32 v4, v3
    s_sub_u32 s16, s16, 1
    s_cbranch_scc1 L_ld21
    s_waitcnt lgkmcnt(0)
    v_cmp_gt_u32 vcc, 4, v4
    s_cbranch_vccnz L_lw20
L_ld21:
    s_lshl_b32 s47, s40, 10
    s_add_u32 s47, s47, 67584
    v_lshl_add_u32 v3, v2, 2, s47
    v_lshlrev_b32 v4, 4, v2
    s_lshl_b32 s47, s40, 12
    s_lshl_b32 s48, s23, 14
    s_add_u32 s47, s47, s48
    s_add_u32 s47, s47, 8388608
    ds_read2st64_b32 v[32:33], v3 offset0:0 offset1:16
    ds_read2st64_b32 v[34:35], v3 offset0:160 offset1:176
    ds_read2st64_b32 v[36:37], v3 offset0:1 offset1:17
    ds_read2st64_b32 v[38:39], v3 offset0:161 offset1:177
    ds_read2st64_b32 v[40:41], v3 offset0:2 offset1:18
    ds_read2st64_b32 v[42:43], v3 offset0:162 offset1:178
    ds_read2st64_b32 v[44:45], v3 offset0:3 offset1:19
    ds_read2st64_b32 v[46:47], v3 offset0:163 offset1:179
    s_waitcnt lgkmcnt(6)
    buffer_store_dwordx4 v[32:35], v4, s[32:35], s47 offen offset:0 sc1
    s_waitcnt lgkmcnt(4)
    buffer_store_dwordx4 v[36:39], v4, s[32:35], s47 offen offset:1024 sc1
    s_waitcnt lgkmcnt(2)
    buffer_store_dwordx4 v[40:43], v4, s[32:35], s47 offen offset:2048 sc1
    s_waitcnt lgkmcnt(0)
    buffer_store_dwordx4 v[44:47], v4, s[32:35], s47 offen offset:3072 sc1
    s_lshl_b32 s47, s21, 2
    s_add_u32 s47, s47, s40
    s_lshl_b32 s47, s47, 4
    s_add_u32 s47, s47, s20
    s_lshl_b32 s47, s47, 7
    s_add_u32 s47, s47, 18481152
    s_waitcnt vmcnt(0)
    v_lshlrev_b32 v3, 26, v2
    v_mov_b32 v4, s54
    buffer_store_dword v4, v3, s[32:35], s47 offen sc1
    s_setprio 0
    s_cmp_eq_u32 s40, 0
    s_cbranch_scc0 L_noap
    s_lshl_b32 s47, s97, 2
L_hop12:
    s_cbranch_execz L_hopback
    s_lshr_b32 s48, s96, 2
    s_add_u32 s47, s47, s48
    s_lshl_b32 s47, s47, 11
    s_add_u32 s47, s47, 18481152
    v_and_b32 v5, 15, v2
    v_lshlrev_b32 v5, 7, v5
    v_mov_b32 v3, 163636
    s_mov_b32 s16, 200000
L_lw22:
    ds_read_b32 v4, v3
    s_sub_u32 s16, s16, 1
    s_cbranch_scc1 L_ld23
    s_waitcnt lgkmcnt(0)
    v_cmp_gt_u32 vcc, 1, v4
    s_cbranch_vccnz L_lw22
L_ld23:
    s_mov_b32 s16, 200000
L_pg24:
    buffer_load_dword v6, v5, s[32:35], s47 offen sc1
    s_sub_u32 s16, s16, 1
    s_cbranch_scc1 L_pd25
    s_waitcnt vmcnt(0)
    v_cmp_ne_u32 vcc, s54, v6
    s_cbranch_vccnz L_pg24
L_pd25:
L_noap:
    v_mov_b32 v3, 163612
    v_mov_b32 v4, 1
    s_mov_b64 exec, 1
    ds_add_u32 v3, v4
    s_mov_b64 exec, -1
    s_endpgm
L_aux:
    s_waitcnt lgkmcnt(0)
    s_barrier
    v_lshlrev_b32 v68, 16, v64
    v_lshlrev_b32 v69, 16, v66
    v_and_b32 v70, 0xffff0000, v64
    v_and_b32 v71, 0xffff0000, v66
    v_fmac_f32 v76, v68, v69
    v_fmac_f32 v76, v70, v71
    v_lshlrev_b32 v68, 16, v65
    v_lshlrev_b32 v69, 16, v67
    v_and_b32 v70, 0xffff0000, v65
    v_and_b32 v71, 0xffff0000, v67
    v_fmac_f32 v76, v68, v69
    v_fmac_f32 v76, v70, v71
L_aux0:
    s_lshl_b32 s47, s57, 7
    v_add_u32 v64, s56, v250
    v_add_u32 v66, s47, v251
    ds_read_b64 v[64:65], v64
    ds_read_b64 v[66:67], v66
    s_sub_u32 s47, s49, s55
    s_cmp_lt_u32 s47, 5
    s_cbranch_scc1 L_xut
L_xa:
    s_bitcmp1_b32 21056, s49
    s_cbranch_scc1 L_xev
L_xd:
    s_add_u32 s57, s57, 1
    s_and_b32 s57, s57, 15
    s_add_u32 s56, s56, 40960
    s_cmp_eq_u32 s56, 157696
    s_cselect_b32 s56, 34816, s56
    s_add_u32 s49, s49, 1
    s_setpc_b64 s[70:71]
L_xut:
    s_cmp_eq_u32 s47, 0
    s_cbranch_scc0 L_xst
    ds_read_b64_tr_b16 v[32:33], v20 offset:0
    ds_read_b64_tr_b16 v[34:35], v20 offset:2048
    ds_read_b64_tr_b16 v[40:41], v20 offset:128
    ds_read_b64_tr_b16 v[42:43], v20 offset:2176
    ds_read_b64_tr_b16 v[48:49], v21 offset:256
    ds_read_b64_tr_b16 v[50:51], v21 offset:2304
    ds_read_b64_tr_b16 v[56:57], v21 offset:384
    ds_read_b64_tr_b16 v[58:59], v21 offset:2432
    ds_read_b64_tr_b16 v[36:37], v22 offset:0
    ds_read_b64_tr_b16 v[38:39], v22 offset:2048
    ds_read_b64_tr_b16 v[44:45], v22 offset:128
    ds_read_b64_tr_b16 v[46:47], v22 offset:2176
    ds_read_b64_tr_b16 v[52:53], v23 offset:256
    ds_read_b64_tr_b16 v[54:55], v23 offset:2304
    ds_read_b64_tr_b16 v[60:61], v23 offset:384
    ds_read_b64_tr_b16 v[62:63], v23 offset:2432
    s_branch L_xa
L_xst:
    s_add_u32 s47, s59, 65536
    buffer_store_dwordx4 v[32:35], v26, s[32:35], s59 offen sc1
    buffer_store_dwordx4 v[36:39], v26, s[32:35], s47 offen sc1
    s_add_u32 s59, s59, 256
    v_mov_b64 v[32:33], v[40:41]
    v_mov_b64 v[34:35], v[42:43]
    v_mov_b64 v[36:37], v[44:45]
    v_mov_b64 v[38:39], v[46:47]
    v_mov_b64 v[40:41], v[48:49]
    v_mov_b64 v[42:43], v[50:51]
    v_mov_b64 v[44:45], v[52:53]
    v_mov_b64 v[46:47], v[54:55]
    v_mov_b64 v[48:49], v[56:57]
    v_mov_b64 v[50:51], v[58:59]
    v_mov_b64 v[52:53], v[60:61]
    v_mov_b64 v[54:55], v[62:63]
    s_branch L_xa
L_xev:
    v_mov_b32 v3, 0
    s_cmp_eq_u32 s49, 6
    s_cbranch_scc0 L_x9
    global_load_dword v27, v3, s[12:13] sc1
    s_branch L_xd
L_x9:
    s_cmp_eq_u32 s49, 9
    s_cbranch_scc0 L_x12
    s_mov_b32 s16, 200000
    s_waitcnt vmcnt(0)
L_nsp:
    v_readfirstlane_b32 s54, v27
    s_nop 0
    s_cmp_lg_u32 s54, 0
    s_cbranch_scc1 L_nok
    global_load_dword v27, v3, s[12:13] sc1
    s_waitcnt vmcnt(0)
    s_sub_u32 s16, s16, 1
    s_cbranch_scc0 L_nsp
L_nok:
    buffer_store_dword v27, v25, s[32:35], s60 offen sc1
    s_branch L_xd
L_x12:
    v_and_b32 v3, 15, v2
    v_lshlrev_b32 v3, 7, v3
    s_cmp_eq_u32 s49, 12
    s_cbranch_scc0 L_x14
    buffer_load_dword v27, v3, s[32:35], s61 offen sc1
    s_branch L_xd
L_x14:
    s_waitcnt vmcnt(0)
    s_mov_b32 s16, 200000
    v_cmp_ne_u32 vcc, s54, v27
    s_cbranch_vccz L_pd27
L_pg26:
    buffer_load_dword v27, v3, s[32:35], s61 offen sc1
    s_sub_u32 s16, s16, 1
    s_cbranch_scc1 L_pd27
    s_waitcnt vmcnt(0)
    v_cmp_ne_u32 vcc, s54, v27
    s_cbranch_vccnz L_pg26
L_pd27:
    s_lshl_b32 s47, s58, 13
    s_add_u32 m0, s47, 17664
    s_mov_b64 vcc, -1
    buffer_load_dwordx4 v9, s[32:35], s62 offen offset:0 sc1 lds
    buffer_load_dwordx4 v9, s[32:35], s62 offen offset:1024 sc1 lds
    buffer_load_dwordx4 v9, s[32:35], s62 offen offset:2048 sc1 lds
    buffer_load_dwordx4 v9, s[32:35], s62 offen offset:3072 sc1 lds
    s_add_u32 m0, m0, 4096
    s_add_u32 s62, s62, 4096
    buffer_load_dwordx4 v9, s[32:35], s62 offen offset:0 sc1 lds
    buffer_load_dwordx4 v9, s[32:35], s62 offen offset:1024 sc1 lds
    buffer_load_dwordx4 v9, s[32:35], s62 offen offset:2048 sc1 lds
    buffer_load_dwordx4 v9, s[32:35], s62 offen offset:3072 sc1 lds
    s_branch L_xd
L_cons:
    s_or_b32 s45, s2, s22
    s_cbranch_scc1 L_nonn
    s_mul_i32 s46, s16, 1664525
    s_add_u32 s46, s46, 1013904223
    s_max_u32 s54, s46, 1
    s_mov_b32 s45, 17997824
    v_mov_b32 v4, 0
    v_mov_b32 v5, s54
    s_mov_b64 exec, 1
    global_store_dword v4, v5, s[12:13] sc1
    s_mov_b64 exec, -1
    v_lshlrev_b32 v6, 26, v2
    v_mov_b32 v7, s54
    buffer_store_dword v7, v6, s[32:35], s45 offen sc1
L_nonn:
    s_mov_b64 s[24:25], s[68:69]
    s_lshr_b32 s40, s22, 1
    s_and_b32 s41, s22, 1
    s_lshl_b32 s42, s40, 13
    v_and_b32 v3, 15, v2
    v_lshrrev_b32 v4, 4, v2
    v_lshrrev_b32 v5, 1, v3
    v_lshlrev_b32 v6, 7, v3
    v_add_u32 v6, s42, v6
    v_xor_b32 v7, v4, v5
    v_lshl_add_u32 v10, v7, 4, v6
    v_add_u32 v7, 4, v4
    v_xor_b32 v7, v7, v5
    v_lshl_add_u32 v11, v7, 4, v6
    v_bfe_u32 v8, v2, 2, 2
    v_and_b32 v9, 3, v2
    v_lshrrev_b32 v5, 1, v8
    v_and_b32 v7, 1, v4
    v_lshl_add_u32 v5, v7, 1, v5
    s_lshl_b32 s42, s41, 1
    s_add_u32 s42, s42, s40
    v_xor_b32 v5, s42, v5
    v_lshl_add_u32 v8, v4, 3, v8
    v_lshlrev_b32 v8, 7, v8
    v_lshl_add_u32 v8, v9, 3, v8
    v_add_u32 v8, 16384, v8
    v_lshl_add_u32 v12, v5, 5, v8
    v_xor_b32 v13, 32, v12
    v_add_u32 v16, 75776, v10
L_hop13:
    s_cbranch_execz L_hopback
    v_add_u32 v17, 75776, v11
    v_add_u32 v18, 75776, v12
    v_add_u32 v19, 75776, v13
    s_cmp_eq_u32 s40, 0
    s_mov_b32 s47, 157696
    s_cselect_b32 s47, 149504, s47
    s_mov_b32 s48, 149504
    s_cselect_b32 s48, 157696, s48
    s_mov_b32 s49, 108552
    s_cselect_b32 s49, 67584, s49
    s_mov_b32 s50, 149504
    s_cselect_b32 s50, 67584, s50
    s_mov_b32 s51, 157696
    s_cselect_b32 s51, 108544, s51
    s_cmp_eq_u32 s41, 0
    s_cselect_b32 s50, s50, s51
    s_mul_i32 s51, s41, 2112
    s_add_u32 s47, s47, s51
    s_add_u32 s48, s48, s51
    v_lshlrev_b32 v14, 4, v2
    v_add_u32 v20, s47, v14
    v_add_u32 v21, s48, v14
    v_and_b32 v5, 48, v2
    v_add_u32 v23, s48, v5
    v_add_u32 v22, s47, v5
    s_lshl_b32 s51, s41, 12
    s_add_u32 s49, s49, s51
    v_add_u32 v248, s49, v14
    v_xor_b32 v249, 8, v248
    s_add_u32 s51, s51, 67584
    v_add_u32 v250, s51, v14
    s_lshl_b32 s58, s41, 2
    s_add_u32 s58, s58, 163584
    s_lshl_b32 s47, s21, 1
    s_add_u32 s47, s47, s41
    s_lshl_b32 s48, s47, 1
    s_add_u32 s48, s48, s40
    s_lshl_b32 s59, s48, 14
    s_add_u32 s59, s59, 16777216
    s_lshl_b32 s62, s48, 9
    s_lshl_b32 s48, s20, 10
    s_add_u32 s56, s59, s48
    s_lshl_b32 s60, s47, 11
    s_add_u32 s60, s60, 17825792
    s_lshl_b32 s48, s20, 7
    s_add_u32 s57, s60, s48
    s_lshl_b32 s48, s40, 4
    s_add_u32 s57, s57, s48
    s_xor_b32 s61, s20, s40
    s_lshl_b32 s48, s20, 18
    s_add_u32 s62, s62, s48
    s_add_u32 s62, s62, 4194304
    v_lshlrev_b32 v5, 5, v4
    v_lshl_add_u32 v15, v3, 26, v5
    v_lshl_add_u32 v236, v3, 7, v5
    v_lshlrev_b32 v251, 7, v3
    v_lshlrev_b32 v5, 4, v3
    v_bfe_u32 v7, v2, 4, 1
    v_lshl_add_u32 v5, v7, 15, v5
    v_lshrrev_b32 v6, 5, v2
    v_lshl_add_u32 v237, v6, 8, v5
    s_lshl_b32 s52, s21, 11
    s_add_u32 s52, s52, 18219008
    s_lshl_b32 s48, s20, 7
    s_add_u32 s53, s52, s48
    s_lshl_b32 s47, s20, 4
    s_add_u32 s47, s47, s21
    s_lshl_b32 s47, s47, 7
    s_add_u32 s63, s47, 18350080
    s_lshl_b32 s55, s96, 11
    s_add_u32 s55, s55, 18350080
    v_and_b32 v5, 1, v2
    v_lshlrev_b32 v5, 4, v5
    v_mov_b32 v8, 0x3f80
    v_lshlrev_b32 v5, v5, v8
    v_bfe_u32 v8, v2, 2, 2
    v_cmp_eq_u32 vcc, v8, v4
    s_nop 1
    v_cndmask_b32 v5, 0, v5, vcc
    v_and_b32 v9, 2, v2
    v_cmp_eq_u32 vcc, 0, v9
    s_nop 1
    v_cndmask_b32 v232, 0, v5, vcc
    v_cndmask_b32 v233, v5, 0, vcc
    v_mov_b64 v[234:235], v[232:233]
    v_and_b32 v9, 3, v2
    v_lshrrev_b32 v5, 1, v8
    v_lshl_add_u32 v8, v6, 3, v8
    v_lshlrev_b32 v8, 7, v8
    v_lshl_add_u32 v8, v7, 5, v8
    v_lshl_add_u32 v8, v9, 3, v8
    v_add_u32 v8, 116736, v8
    v_lshl_add_u32 v244, v5, 6, v8
    v_xor_b32 v245, 64, v244
    s_lshl_b32 s17, s96, 18
    s_lshl_b32 s48, s22, 16
    s_add_u32 s17, s17, s48
    s_add_u32 s17, s17, 4194304
    s_lshl_b32 s99, s98, 12
    v_and_b32 v5, 31, v2
    v_mul_u32_u24 v8, 144, v5
    v_lshl_add_u32 v8, v6, 3, v8
    v_add_u32 v242, s50, v8
    v_lshlrev_b32 v246, 2, v5
    v_lshlrev_b32 v5, 4, v5
    v_lshl_add_u32 v247, v6, 14, v5
    v_lshrrev_b32 v4, 3, v2
    v_and_b32 v5, 7, v2
    v_mul_u32_u24 v6, 144, v4
    v_lshl_add_u32 v6, v5, 4, v6
    v_add_u32 v243, s50, v6
    v_lshlrev_b32 v4, 11, v4
    v_lshl_add_u32 v241, v5, 4, v4
    s_lshl_b32 s67, s96, 2
    s_add_u32 s67, s67, s22
    s_lshl_b32 s65, s67, 7
    s_add_u32 s65, s65, 17891328
    s_lshl_b32 s67, s67, 16
    s_lshl_b32 s48, s97, 7
    s_add_u32 s67, s67, s48
    s_lshl_b32 s48, s41, 9
    s_lshl_b32 s64, s96, 10
    s_add_u32 s64, s64, s48
    s_lshl_b32 s48, s97, 18
    s_add_u32 s64, s64, s48
    s_add_u32 s64, s64, 8388608
    s_cmp_eq_u32 s40, 0
    s_mov_b32 s66, 0x03020c0c
    s_cselect_b32 s66, 0x01000c0c, s66
    s_mov_b32 s44, 1069066811
    s_mov_b32 s45, 1069066811
    s_mov_b32 s46, 897988541
    v_lshrrev_b32 v3, 3, v2
    v_and_b32 v4, 7, v2
    v_bfe_u32 v5, v3, 1, 1
    v_lshlrev_b32 v5, 2, v5
    v_xor_b32 v4, v4, v5
    v_lshlrev_b32 v3, 11, v3
    s_lshl_b32 s47, s97, 7
    v_add_u32 v3, s47, v3
    v_lshl_add_u32 v238, v4, 4, v3
    v_add_u32 v239, 16384, v238
    s_setprio 2
    v_mov_b64 v[104:105], 0
    v_mov_b64 v[106:107], 0
    v_mov_b64 v[108:109], 0
    v_mov_b64 v[110:111], 0
    v_mov_b64 v[112:113], 0
    v_mov_b64 v[114:115], 0
    v_mov_b64 v[116:117], 0
    v_mov_b64 v[118:119], 0
    v_mov_b64 v[120:121], 0
    v_mov_b64 v[122:123], 0
    v_mov_b64 v[124:125], 0
    v_mov_b64 v[126:127], 0
    v_mov_b64 v[128:129], 0
    v_mov_b64 v[130:131], 0
    v_mov_b64 v[132:133], 0
    v_mov_b64 v[134:135], 0
    v_mov_b64 v[136:137], 0
    v_mov_b64 v[138:139], 0
    v_mov_b64 v[140:141], 0
    v_mov_b64 v[142:143], 0
    v_mov_b64 v[144:145], 0
    v_mov_b64 v[146:147], 0
    v_mov_b64 v[148:149], 0
    v_mov_b64 v[150:151], 0
    v_mov_b64 v[152:153], 0
    v_mov_b64 v[154:155], 0
    v_mov_b64 v[156:157], 0
    v_mov_b64 v[158:159], 0
    v_mov_b64 v[160:161], 0
    v_mov_b64 v[162:163], 0
    v_mov_b64 v[164:165], 0
    v_mov_b64 v[166:167], 0
    v_mov_b64 v[168:169], 0
    v_mov_b64 v[170:171], 0
    v_mov_b64 v[172:173], 0
    v_mov_b64 v[174:175], 0
    v_mov_b64 v[176:177], 0
    v_mov_b64 v[178:179], 0
    v_mov_b64 v[180:181], 0
    v_mov_b64 v[182:183], 0
    v_mov_b64 v[184:185], 0
    v_mov_b64 v[186:187], 0
    v_mov_b64 v[188:189], 0
    v_mov_b64 v[190:191], 0
    v_mov_b64 v[192:193], 0
    v_mov_b64 v[194:195], 0
    v_mov_b64 v[196:197], 0
    v_mov_b64 v[198:199], 0
    s_mov_b32 s42, 75776
    s_mov_b32 s43, 0
    s_waitcnt lgkmcnt(0)
    s_barrier
    ds_read_b64_tr_b16 v[40:41], v18 offset:0
    ds_read_b64_tr_b16 v[42:43], v18 offset:512
    ds_read_b128 v[24:27], v16 offset:0
L_hop14:
    s_cbranch_execz L_hopback
    ds_read_b128 v[28:31], v16 offset:2048
    ds_read_b128 v[32:35], v16 offset:4096
    ds_read_b128 v[36:39], v16 offset:6144
    ds_read_b64_tr_b16 v[44:45], v19 offset:0
    ds_read_b64_tr_b16 v[46:47], v19 offset:512
    ds_read_b64_tr_b16 v[48:49], v18 offset:8192
    ds_read_b64_tr_b16 v[50:51], v18 offset:8704
    ds_read_b64_tr_b16 v[52:53], v19 offset:8192
    ds_read_b64_tr_b16 v[54:55], v19 offset:8704
    ds_read_b64_tr_b16 v[56:57], v18 offset:16384
    ds_read_b64_tr_b16 v[58:59], v18 offset:16896
    ds_read_b64_tr_b16 v[60:61], v19 offset:16384
    ds_read_b64_tr_b16 v[62:63], v19 offset:16896
L_cloop:
    s_waitcnt lgkmcnt(2)
    v_mfma_f32_16x16x32_bf16 v[104:107], v[40:43], v[24:27], v[104:107]
    ds_read_b64_tr_b16 v[80:81], v18 offset:4096
    v_mfma_f32_16x16x32_bf16 v[128:131], v[40:43], v[28:31], v[128:131]
    ds_read_b64_tr_b16 v[82:83], v18 offset:4608
    v_mfma_f32_16x16x32_bf16 v[152:155], v[40:43], v[32:35], v[152:155]
    ds_read_b128 v[64:67], v17 offset:0
    v_mfma_f32_16x16x32_bf16 v[176:179], v[40:43], v[36:39], v[176:179]
    ds_read_b128 v[68:71], v17 offset:2048
    v_mfma_f32_16x16x32_bf16 v[180:183], v[44:47], v[36:39], v[180:183]
    ds_read_b128 v[72:75], v17 offset:4096
    v_mfma_f32_16x16x32_bf16 v[156:159], v[44:47], v[32:35], v[156:159]
    ds_read_b128 v[76:79], v17 offset:6144
    v_mfma_f32_16x16x32_bf16 v[132:135], v[44:47], v[28:31], v[132:135]
    ds_read_b64_tr_b16 v[84:85], v19 offset:4096
    v_mfma_f32_16x16x32_bf16 v[108:111], v[44:47], v[24:27], v[108:111]
    ds_read_b64_tr_b16 v[86:87], v19 offset:4608
    s_waitcnt lgkmcnt(8)
    v_mfma_f32_16x16x32_bf16 v[112:115], v[24:27], v[48:51], v[112:115]
    ds_read_b64_tr_b16 v[88:89], v18 offset:12288
    v_mfma_f32_16x16x32_bf16 v[136:139], v[28:31], v[48:51], v[136:139]
    ds_read_b64_tr_b16 v[90:91], v18 offset:12800
    v_mfma_f32_16x16x32_bf16 v[160:163], v[32:35], v[48:51], v[160:163]
    ds_read_b64_tr_b16 v[92:93], v19 offset:12288
    v_mfma_f32_16x16x32_bf16 v[184:187], v[36:39], v[48:51], v[184:187]
    ds_read_b64_tr_b16 v[94:95], v19 offset:12800
    v_mfma_f32_16x16x32_bf16 v[188:191], v[36:39], v[52:55], v[188:191]
    ds_read_b64_tr_b16 v[96:97], v18 offset:20480
    v_mfma_f32_16x16x32_bf16 v[164:167], v[32:35], v[52:55], v[164:167]
    ds_read_b64_tr_b16 v[98:99], v18 offset:20992
    v_mfma_f32_16x16x32_bf16 v[140:143], v[28:31], v[52:55], v[140:143]
    ds_read_b64_tr_b16 v[100:101], v19 offset:20480
    v_mfma_f32_16x16x32_bf16 v[116:119], v[24:27], v[52:55], v[116:119]
    ds_read_b64_tr_b16 v[102:103], v19 offset:20992
    v_mfma_f32_16x16x32_bf16 v[120:123], v[24:27], v[56:59], v[120:123]
    v_mfma_f32_16x16x32_bf16 v[144:147], v[28:31], v[56:59], v[144:147]
    s_add_u32 s42, s42, 40960
    v_mfma_f32_16x16x32_bf16 v[168:171], v[32:35], v[56:59], v[168:171]
    s_cmp_eq_u32 s42, 157696
    v_mfma_f32_16x16x32_bf16 v[192:195], v[36:39], v[56:59], v[192:195]
    s_cselect_b32 s42, 34816, s42
    v_mfma_f32_16x16x32_bf16 v[196:199], v[36:39], v[60:63], v[196:199]
    v_add_u32 v18, s42, v12
    s_add_u32 s43, s43, 1
    v_mfma_f32_16x16x32_bf16 v[172:175], v[32:35], v[60:63], v[172:175]
    v_add_u32 v16, s42, v10
    s_cmp_eq_u32 s43, 16
    v_mfma_f32_16x16x32_bf16 v[148:151], v[28:31], v[60:63], v[148:151]
    v_add_u32 v19, s42, v13
    v_mfma_f32_16x16x32_bf16 v[124:127], v[24:27], v[60:63], v[124:127]
    s_waitcnt lgkmcnt(0)
    s_cbranch_scc1 L_clast
    v_mfma_f32_16x16x32_bf16 v[104:107], v[80:83], v[64:67], v[104:107]
    s_barrier
    v_mfma_f32_16x16x32_bf16 v[128:131], v[80:83], v[68:71], v[128:131]
    ds_read_b64_tr_b16 v[40:41], v18 offset:0
    v_mfma_f32_16x16x32_bf16 v[152:155], v[80:83], v[72:75], v[152:155]
    ds_read_b64_tr_b16 v[42:43], v18 offset:512
    v_mfma_f32_16x16x32_bf16 v[176:179], v[80:83], v[76:79], v[176:179]
    ds_read_b128 v[24:27], v16 offset:0
    v_mfma_f32_16x16x32_bf16 v[180:183], v[84:87], v[76:79], v[180:183]
    ds_read_b128 v[28:31], v16 offset:2048
    v_mfma_f32_16x16x32_bf16 v[156:159], v[84:87], v[72:75], v[156:159]
    ds_read_b128 v[32:35], v16 offset:4096
    v_mfma_f32_16x16x32_bf16 v[132:135], v[84:87], v[68:71], v[132:135]
    ds_read_b128 v[36:39], v16 offset:6144
    v_mfma_f32_16x16x32_bf16 v[108:111], v[84:87], v[64:67], v[108:111]
    ds_read_b64_tr_b16 v[44:45], v19 offset:0
    v_mfma_f32_16x16x32_bf16 v[112:115], v[64:67], v[88:91], v[112:115]
    ds_read_b64_tr_b16 v[46:47], v19 offset:512
    v_mfma_f32_16x16x32_bf16 v[136:139], v[68:71], v[88:91], v[136:139]
    ds_read_b64_tr_b16 v[48:49], v18 offset:8192
    v_mfma_f32_16x16x32_bf16 v[160:163], v[72:75], v[88:91], v[160:163]
    ds_read_b64_tr_b16 v[50:51], v18 offset:8704
    v_mfma_f32_16x16x32_bf16 v[184:187], v[76:79], v[88:91], v[184:187]
    ds_read_b64_tr_b16 v[52:53], v19 offset:8192
    v_mfma_f32_16x16x32_bf16 v[188:191], v[76:79], v[92:95], v[188:191]
    ds_read_b64_tr_b16 v[54:55], v19 offset:8704
    v_mfma_f32_16x16x32_bf16 v[164:167], v[72:75], v[92:95], v[164:167]
    ds_read_b64_tr_b16 v[56:57], v18 offset:16384
    v_mfma_f32_16x16x32_bf16 v[140:143], v[68:71], v[92:95], v[140:143]
    ds_read_b64_tr_b16 v[58:59], v18 offset:16896
    v_mfma_f32_16x16x32_bf16 v[116:119], v[64:67], v[92:95], v[116:119]
    ds_read_b64_tr_b16 v[60:61], v19 offset:16384
    v_mfma_f32_16x16x32_bf16 v[120:123], v[64:67], v[96:99], v[120:123]
    ds_read_b64_tr_b16 v[62:63], v19 offset:16896
    v_mfma_f32_16x16x32_bf16 v[144:147], v[68:71], v[96:99], v[144:147]
    v_mfma_f32_16x16x32_bf16 v[168:171], v[72:75], v[96:99], v[168:171]
    v_mfma_f32_16x16x32_bf16 v[192:195], v[76:79], v[96:99], v[192:195]
    v_mfma_f32_16x16x32_bf16 v[196:199], v[76:79], v[100:103], v[196:199]
    v_add_u32 v17, s42, v11
    v_mfma_f32_16x16x32_bf16 v[172:175], v[72:75], v[100:103], v[172:175]
    v_mfma_f32_16x16x32_bf16 v[148:151], v[68:71], v[100:103], v[148:151]
    v_mfma_f32_16x16x32_bf16 v[124:127], v[64:67], v[100:103], v[124:127]
    s_branch L_cloop
L_clast:
    v_mfma_f32_16x16x32_bf16 v[112:115], v[64:67], v[88:91], v[112:115]
    s_barrier
    s_load_dword s54, s[12:13], 0
    v_mfma_f32_16x16x32_bf16 v[136:139], v[68:71], v[88:91], v[136:139]
    v_mov_b32 v56, 0x3f803f80
    v_mfma_f32_16x16x32_bf16 v[160:163], v[72:75], v[88:91], v[160:163]
    v_mov_b32 v57, 0x3f803f80
    v_mfma_f32_16x16x32_bf16 v[184:187], v[76:79], v[88:91], v[184:187]
    v_mov_b32 v58, 0x3f803f80
    v_mfma_f32_16x16x32_bf16 v[188:191], v[76:79], v[92:95], v[188:191]
    v_mov_b32 v59, 0x3f803f80
    v_mfma_f32_16x16x32_bf16 v[164:167], v[72:75], v[92:95], v[164:167]
    v_mfma_f32_16x16x32_bf16 v[140:143], v[68:71], v[92:95], v[140:143]
    v_mfma_f32_16x16x32_bf16 v[116:119], v[64:67], v[92:95], v[116:119]
    v_mfma_f32_16x16x32_bf16 v[120:123], v[64:67], v[96:99], v[120:123]
    v_mfma_f32_16x16x32_bf16 v[144:147], v[68:71], v[96:99], v[144:147]
    v_mfma_f32_16x16x32_bf16 v[168:171], v[72:75], v[96:99], v[168:171]
    v_mul_f32 v200, s44, v112
    v_mul_f32 v201, s44, v113
    v_mfma_f32_16x16x32_bf16 v[192:195], v[76:79], v[96:99], v[192:195]
    v_mul_f32 v202, s44, v114
    v_mul_f32 v203, s44, v115
    v_mfma_f32_16x16x32_bf16 v[196:199], v[76:79], v[100:103], v[196:199]
    v_mul_f32 v204, s44, v136
    v_mul_f32 v205, s44, v137
    v_mfma_f32_16x16x32_bf16 v[172:175], v[72:75], v[100:103], v[172:175]
    v_mul_f32 v206, s44, v138
    v_mul_f32 v207, s44, v139
    v_mfma_f32_16x16x32_bf16 v[148:151], v[68:71], v[100:103], v[148:151]
    v_mul_f32 v208, s44, v116
    v_mul_f32 v209, s44, v117
L_hop15:
    s_cbranch_execz L_hopback
    v_mfma_f32_16x16x32_bf16 v[124:127], v[64:67], v[100:103], v[124:127]
    v_mul_f32 v210, s44, v118
    v_mul_f32 v211, s44, v119
    v_mul_f32 v212, s44, v140
    v_mul_f32 v213, s44, v141
    v_mul_f32 v214, s44, v142
    v_mul_f32 v215, s44, v143
    v_exp_f32_e64 v200, v200 clamp
    v_max_f32 v112, s46, v112
    v_exp_f32_e64 v201, v201 clamp
    v_max_f32 v113, s46, v113
    v_exp_f32_e64 v202, v202 clamp
    v_max_f32 v114, s46, v114
    v_exp_f32_e64 v203, v203 clamp
    v_max_f32 v115, s46, v115
    v_exp_f32_e64 v204, v204 clamp
    v_max_f32 v136, s46, v136
    v_exp_f32_e64 v205, v205 clamp
    v_max_f32 v137, s46, v137
    v_exp_f32_e64 v206, v206 clamp
    v_max_f32 v138, s46, v138
    v_exp_f32_e64 v207, v207 clamp
    v_max_f32 v139, s46, v139
    v_exp_f32_e64 v208, v208 clamp
    v_max_f32 v116, s46, v116
    v_exp_f32_e64 v209, v209 clamp
    v_max_f32 v117, s46, v117
    v_exp_f32_e64 v210, v210 clamp
    v_max_f32 v118, s46, v118
    v_exp_f32_e64 v211, v211 clamp
    v_max_f32 v119, s46, v119
    v_exp_f32_e64 v212, v212 clamp
    v_max_f32 v140, s46, v140
    v_exp_f32_e64 v213, v213 clamp
    v_max_f32 v141, s46, v141
    v_exp_f32_e64 v214, v214 clamp
    v_max_f32 v142, s46, v142
    v_exp_f32_e64 v215, v215 clamp
    v_max_f32 v143, s46, v143
    v_pk_add_f32 v[112:113], v[112:113], v[200:201]
    v_pk_add_f32 v[114:115], v[114:115], v[202:203]
    v_pk_add_f32 v[136:137], v[136:137], v[204:205]
    v_pk_add_f32 v[138:139], v[138:139], v[206:207]
    v_pk_add_f32 v[116:117], v[116:117], v[208:209]
    v_pk_add_f32 v[118:119], v[118:119], v[210:211]
    v_pk_add_f32 v[140:141], v[140:141], v[212:213]
    v_pk_add_f32 v[142:143], v[142:143], v[214:215]
    v_cvt_pk_bf16_f32 v40, v120, v121
    v_cvt_pk_bf16_f32 v41, v122, v123
    v_cvt_pk_bf16_f32 v42, v144, v145
    v_cvt_pk_bf16_f32 v43, v146, v147
    v_cvt_pk_bf16_f32 v44, v168, v169
    v_cvt_pk_bf16_f32 v45, v170, v171
    v_cvt_pk_bf16_f32 v46, v192, v193
    v_cvt_pk_bf16_f32 v47, v194, v195
    v_cvt_pk_bf16_f32 v48, v124, v125
    v_cvt_pk_bf16_f32 v49, v126, v127
    v_cvt_pk_bf16_f32 v50, v148, v149
    v_cvt_pk_bf16_f32 v51, v150, v151
    v_cvt_pk_bf16_f32 v52, v172, v173
    v_cvt_pk_bf16_f32 v53, v174, v175
    v_cvt_pk_bf16_f32 v54, v196, v197
    v_cvt_pk_bf16_f32 v55, v198, v199
    v_cvt_pk_bf16_f32 v24, v112, v113
    v_cvt_pk_bf16_f32 v25, v114, v115
    v_cvt_pk_bf16_f32 v26, v136, v137
    v_cvt_pk_bf16_f32 v27, v138, v139
    v_cvt_pk_bf16_f32 v32, v116, v117
    v_cvt_pk_bf16_f32 v33, v118, v119
    v_cvt_pk_bf16_f32 v34, v140, v141
    v_cvt_pk_bf16_f32 v35, v142, v143
    v_pk_mul_f32 v[200:201], v[160:161], s[44:45]
    v_pk_mul_f32 v[202:203], v[162:163], s[44:45]
    v_pk_mul_f32 v[204:205], v[184:185], s[44:45]
    v_pk_mul_f32 v[206:207], v[186:187], s[44:45]
    v_pk_mul_f32 v[208:209], v[164:165], s[44:45]
    v_pk_mul_f32 v[210:211], v[166:167], s[44:45]
    v_pk_mul_f32 v[212:213], v[188:189], s[44:45]
    v_pk_mul_f32 v[214:215], v[190:191], s[44:45]
    v_exp_f32_e64 v200, v200 clamp
    v_max_f32 v160, s46, v160
    v_exp_f32_e64 v201, v201 clamp
    v_max_f32 v161, s46, v161
    v_exp_f32_e64 v202, v202 clamp
    v_max_f32 v162, s46, v162
    v_exp_f32_e64 v203, v203 clamp
    v_max_f32 v163, s46, v163
    v_exp_f32_e64 v204, v204 clamp
    v_max_f32 v184, s46, v184
    v_exp_f32_e64 v205, v205 clamp
    v_max_f32 v185, s46, v185
    v_exp_f32_e64 v206, v206 clamp
    v_max_f32 v186, s46, v186
    v_exp_f32_e64 v207, v207 clamp
    v_max_f32 v187, s46, v187
    v_exp_f32_e64 v208, v208 clamp
    v_max_f32 v164, s46, v164
    v_exp_f32_e64 v209, v209 clamp
    v_max_f32 v165, s46, v165
    v_exp_f32_e64 v210, v210 clamp
    v_max_f32 v166, s46, v166
    v_exp_f32_e64 v211, v211 clamp
    v_max_f32 v167, s46, v167
    v_exp_f32_e64 v212, v212 clamp
    v_max_f32 v188, s46, v188
    v_exp_f32_e64 v213, v213 clamp
    v_max_f32 v189, s46, v189
    v_exp_f32_e64 v214, v214 clamp
    v_max_f32 v190, s46, v190
    v_exp_f32_e64 v215, v215 clamp
    v_max_f32 v191, s46, v191
    v_pk_add_f32 v[160:161], v[160:161], v[200:201]
    v_pk_add_f32 v[162:163], v[162:163], v[202:203]
    v_pk_add_f32 v[184:185], v[184:185], v[204:205]
    v_pk_add_f32 v[186:187], v[186:187], v[206:207]
    v_pk_add_f32 v[164:165], v[164:165], v[208:209]
    v_pk_add_f32 v[166:167], v[166:167], v[210:211]
    v_pk_add_f32 v[188:189], v[188:189], v[212:213]
    v_pk_add_f32 v[190:191], v[190:191], v[214:215]
    v_cvt_pk_bf16_f32 v28, v160, v161
    v_cvt_pk_bf16_f32 v29, v162, v163
    v_cvt_pk_bf16_f32 v30, v184, v185
    v_cvt_pk_bf16_f32 v31, v186, v187
    v_cvt_pk_bf16_f32 v36, v164, v165
    v_cvt_pk_bf16_f32 v37, v166, v167
    v_cvt_pk_bf16_f32 v38, v188, v189
    v_cvt_pk_bf16_f32 v39, v190, v191
    v_mfma_f32_16x16x32_bf16 v[144:147], v[24:27], v[48:51], 0
    v_mfma_f32_16x16x32_bf16 v[148:151], v[32:35], v[48:51], 0
    v_mfma_f32_16x16x32_bf16 v[172:175], v[32:35], v[56:59], 0
    v_mfma_f32_16x16x32_bf16 v[144:147], v[28:31], v[52:55], v[144:147]
    v_mfma_f32_16x16x32_bf16 v[148:151], v[36:39], v[52:55], v[148:151]
    v_mfma_f32_16x16x32_bf16 v[172:175], v[36:39], v[56:59], v[172:175]
    v_mfma_f32_16x16x32_bf16 v[120:123], v[24:27], v[40:43], 0
    v_mfma_f32_16x16x32_bf16 v[124:127], v[32:35], v[40:43], 0
    v_mfma_f32_16x16x32_bf16 v[168:171], v[24:27], v[56:59], 0
    v_mfma_f32_16x16x32_bf16 v[120:123], v[28:31], v[44:47], v[120:123]
    v_mfma_f32_16x16x32_bf16 v[124:127], v[36:39], v[44:47], v[124:127]
    v_mfma_f32_16x16x32_bf16 v[168:171], v[28:31], v[56:59], v[168:171]
    ds_write_b128 v20, v[144:147] offset:1024
    ds_write_b128 v20, v[148:151]
    ds_write_b128 v22, v[172:175] offset:2048
    v_mov_b32 v8, s58
    v_mov_b32 v9, 1
    s_mov_b64 exec, 1
    ds_add_u32 v8, v9
    s_mov_b64 exec, -1
    v_mfma_f32_16x16x32_bf16 v[104:107], v[80:83], v[64:67], v[104:107]
    v_mfma_f32_16x16x32_bf16 v[128:131], v[80:83], v[68:71], v[128:131]
L_hop16:
    s_cbranch_execz L_hopback
    v_mfma_f32_16x16x32_bf16 v[152:155], v[80:83], v[72:75], v[152:155]
    v_mfma_f32_16x16x32_bf16 v[176:179], v[80:83], v[76:79], v[176:179]
    v_mfma_f32_16x16x32_bf16 v[180:183], v[84:87], v[76:79], v[180:183]
    v_mfma_f32_16x16x32_bf16 v[156:159], v[84:87], v[72:75], v[156:159]
    v_mfma_f32_16x16x32_bf16 v[132:135], v[84:87], v[68:71], v[132:135]
    v_mfma_f32_16x16x32_bf16 v[108:111], v[84:87], v[64:67], v[108:111]
    v_mov_b32 v8, s58
    s_mov_b32 s16, 200000
L_lw28:
    ds_read_b32 v9, v8
    s_sub_u32 s16, s16, 1
    s_cbranch_scc1 L_ld29
    s_waitcnt lgkmcnt(0)
    v_cmp_gt_u32 vcc, 2, v9
    s_cbranch_vccnz L_lw28
L_ld29:
    ds_read_b128 v[144:147], v21
    ds_read_b128 v[148:151], v21 offset:1024
    ds_read_b128 v[172:175], v23 offset:2048
    s_bitcmp1_b32 s61, 0
    s_waitcnt lgkmcnt(1)
    v_pk_add_f32 v[120:121], v[120:121], v[144:145]
    v_pk_add_f32 v[122:123], v[122:123], v[146:147]
    v_pk_add_f32 v[124:125], v[124:125], v[148:149]
    v_pk_add_f32 v[126:127], v[126:127], v[150:151]
    s_cbranch_scc1 L_kvodd
    v_cvt_pk_bf16_f32 v144, v120, v121
    v_cvt_pk_bf16_f32 v145, v122, v123
    v_cvt_pk_bf16_f32 v146, v124, v125
    v_cvt_pk_bf16_f32 v147, v126, v127
    s_branch L_kvst
L_kvodd:
    v_cvt_pk_bf16_f32 v146, v120, v121
    v_cvt_pk_bf16_f32 v147, v122, v123
    v_cvt_pk_bf16_f32 v144, v124, v125
    v_cvt_pk_bf16_f32 v145, v126, v127
L_kvst:
    buffer_store_dwordx4 v[144:147], v14, s[32:35], s56 offen sc1
    s_waitcnt lgkmcnt(0)
    v_pk_add_f32 v[168:169], v[168:169], v[172:173]
    v_pk_add_f32 v[170:171], v[170:171], v[174:175]
    buffer_store_dwordx4 v[168:171], v15, s[32:35], s57 offen sc1
    v_pk_mul_f32 v[200:201], v[104:105], s[44:45]
    v_pk_mul_f32 v[202:203], v[106:107], s[44:45]
    v_pk_mul_f32 v[204:205], v[108:109], s[44:45]
    v_pk_mul_f32 v[206:207], v[110:111], s[44:45]
    v_pk_mul_f32 v[208:209], v[128:129], s[44:45]
    v_pk_mul_f32 v[210:211], v[130:131], s[44:45]
    v_pk_mul_f32 v[212:213], v[132:133], s[44:45]
    v_pk_mul_f32 v[214:215], v[134:135], s[44:45]
    v_exp_f32_e64 v200, v200 clamp
    v_max_f32 v104, s46, v104
    v_exp_f32_e64 v201, v201 clamp
    v_max_f32 v105, s46, v105
    v_exp_f32_e64 v202, v202 clamp
    v_max_f32 v106, s46, v106
    v_exp_f32_e64 v203, v203 clamp
    v_max_f32 v107, s46, v107
    v_exp_f32_e64 v204, v204 clamp
    v_max_f32 v108, s46, v108
    v_exp_f32_e64 v205, v205 clamp
    v_max_f32 v109, s46, v109
    v_exp_f32_e64 v206, v206 clamp
    v_max_f32 v110, s46, v110
    v_exp_f32_e64 v207, v207 clamp
    v_max_f32 v111, s46, v111
    v_exp_f32_e64 v208, v208 clamp
    v_max_f32 v128, s46, v128
    v_exp_f32_e64 v209, v209 clamp
    v_max_f32 v129, s46, v129
    v_exp_f32_e64 v210, v210 clamp
    v_max_f32 v130, s46, v130
    v_exp_f32_e64 v211, v211 clamp
    v_max_f32 v131, s46, v131
    v_exp_f32_e64 v212, v212 clamp
    v_max_f32 v132, s46, v132
    v_exp_f32_e64 v213, v213 clamp
    v_max_f32 v133, s46, v133
    v_exp_f32_e64 v214, v214 clamp
    v_max_f32 v134, s46, v134
    v_exp_f32_e64 v215, v215 clamp
    v_max_f32 v135, s46, v135
    v_pk_add_f32 v[104:105], v[104:105], v[200:201]
    v_pk_add_f32 v[106:107], v[106:107], v[202:203]
    v_pk_add_f32 v[108:109], v[108:109], v[204:205]
    v_pk_add_f32 v[110:111], v[110:111], v[206:207]
    v_pk_add_f32 v[128:129], v[128:129], v[208:209]
    v_pk_add_f32 v[130:131], v[130:131], v[210:211]
    v_pk_add_f32 v[132:133], v[132:133], v[212:213]
    v_pk_add_f32 v[134:135], v[134:135], v[214:215]
    v_cvt_pk_bf16_f32 v88, v104, v105
    v_cvt_pk_bf16_f32 v89, v106, v107
    v_cvt_pk_bf16_f32 v90, v108, v109
    v_cvt_pk_bf16_f32 v91, v110, v111
    ds_write_b64 v248, v[88:89] offset:0
    ds_write_b64 v249, v[90:91] offset:0
    v_cvt_pk_bf16_f32 v92, v128, v129
    v_cvt_pk_bf16_f32 v93, v130, v131
    v_cvt_pk_bf16_f32 v94, v132, v133
    v_cvt_pk_bf16_f32 v95, v134, v135
    ds_write_b64 v248, v[92:93] offset:1024
    ds_write_b64 v249, v[94:95] offset:1024
    v_pk_mul_f32 v[200:201], v[152:153], s[44:45]
    v_pk_mul_f32 v[202:203], v[154:155], s[44:45]
    v_pk_mul_f32 v[204:205], v[156:157], s[44:45]
    v_pk_mul_f32 v[206:207], v[158:159], s[44:45]
    v_pk_mul_f32 v[208:209], v[176:177], s[44:45]
    v_pk_mul_f32 v[210:211], v[178:179], s[44:45]
    v_pk_mul_f32 v[212:213], v[180:181], s[44:45]
    v_pk_mul_f32 v[214:215], v[182:183], s[44:45]
    v_exp_f32_e64 v200, v200 clamp
    v_max_f32 v152, s46, v152
    v_exp_f32_e64 v201, v201 clamp
    v_max_f32 v153, s46, v153
    v_exp_f32_e64 v202, v202 clamp
    v_max_f32 v154, s46, v154
    v_exp_f32_e64 v203, v203 clamp
    v_max_f32 v155, s46, v155
    v_exp_f32_e64 v204, v204 clamp
    v_max_f32 v156, s46, v156
    v_exp_f32_e64 v205, v205 clamp
    v_max_f32 v157, s46, v157
    v_exp_f32_e64 v206, v206 clamp
    v_max_f32 v158, s46, v158
    v_exp_f32_e64 v207, v207 clamp
    v_max_f32 v159, s46, v159
    v_exp_f32_e64 v208, v208 clamp
    v_max_f32 v176, s46, v176
    v_exp_f32_e64 v209, v209 clamp
    v_max_f32 v177, s46, v177
    v_exp_f32_e64 v210, v210 clamp
    v_max_f32 v178, s46, v178
    v_exp_f32_e64 v211, v211 clamp
    v_max_f32 v179, s46, v179
    v_exp_f32_e64 v212, v212 clamp
    v_max_f32 v180, s46, v180
    v_exp_f32_e64 v213, v213 clamp
    v_max_f32 v181, s46, v181
    v_exp_f32_e64 v214, v214 clamp
    v_max_f32 v182, s46, v182
    v_exp_f32_e64 v215, v215 clamp
    v_max_f32 v183, s46, v183
    v_pk_add_f32 v[152:153], v[152:153], v[200:201]
    v_pk_add_f32 v[154:155], v[154:155], v[202:203]
    v_pk_add_f32 v[156:157], v[156:157], v[204:205]
    v_pk_add_f32 v[158:159], v[158:159], v[206:207]
    v_pk_add_f32 v[176:177], v[176:177], v[208:209]
    v_pk_add_f32 v[178:179], v[178:179], v[210:211]
    v_pk_add_f32 v[180:181], v[180:181], v[212:213]
    v_pk_add_f32 v[182:183], v[182:183], v[214:215]
    v_cvt_pk_bf16_f32 v96, v152, v153
    v_cvt_pk_bf16_f32 v97, v154, v155
    v_cvt_pk_bf16_f32 v98, v156, v157
L_hop17:
    s_cbranch_execz L_hopback
    v_cvt_pk_bf16_f32 v99, v158, v159
    ds_write_b64 v248, v[96:97] offset:2048
    ds_write_b64 v249, v[98:99] offset:2048
    v_cvt_pk_bf16_f32 v100, v176, v177
    v_cvt_pk_bf16_f32 v101, v178, v179
    v_cvt_pk_bf16_f32 v102, v180, v181
    v_cvt_pk_bf16_f32 v103, v182, v183
    ds_write_b64 v248, v[100:101] offset:3072
    ds_write_b64 v249, v[102:103] offset:3072
    s_waitcnt vmcnt(0)
    v_mov_b32 v8, 163592
    v_mov_b32 v9, 1
    s_mov_b64 exec, 1
    ds_add_rtn_u32 v9, v8, v9
    s_mov_b64 exec, -1
    s_waitcnt lgkmcnt(0)
    v_readfirstlane_b32 s42, v9
    s_nop 0
    s_cmp_eq_u32 s42, 3
    s_cbranch_scc0 L_nokvf
    v_lshlrev_b32 v6, 26, v2
    v_mov_b32 v7, s54
    buffer_store_dword v7, v6, s[32:35], s53 offen sc1
L_nokvf:
    v_mov_b32 v8, 163592
    s_mov_b32 s16, 200000
L_lw30:
    ds_read_b32 v9, v8
    s_sub_u32 s16, s16, 1
    s_cbranch_scc1 L_ld31
    s_waitcnt lgkmcnt(0)
    v_cmp_gt_u32 vcc, 4, v9
    s_cbranch_vccnz L_lw30
L_ld31:
    ds_read_b128 v[104:107], v250 offset:0
    ds_read_b128 v[108:111], v250 offset:1024
    ds_read_b128 v[112:115], v250 offset:2048
    ds_read_b128 v[116:119], v250 offset:3072
    ds_read_b128 v[120:123], v250 offset:40960
    ds_read_b128 v[124:127], v250 offset:41984
    ds_read_b128 v[128:131], v250 offset:43008
    ds_read_b128 v[132:135], v250 offset:44032
    s_waitcnt lgkmcnt(0)
    v_mov_b32 v8, 163604
    v_mov_b32 v9, 1
    s_mov_b64 exec, 1
    ds_add_u32 v8, v9
    s_mov_b64 exec, -1
    s_cmp_eq_u32 s42, 0
    s_cbranch_scc0 L_kvw
    s_waitcnt vmcnt(0)
    s_mov_b32 s16, 200000
L_pg32:
    buffer_load_dword v7, v251, s[32:35], s52 offen sc1
    s_sub_u32 s16, s16, 1
    s_cbranch_scc1 L_pd33
    s_waitcnt vmcnt(0)
    v_cmp_ne_u32 vcc, s54, v7
    s_cbranch_vccnz L_pg32
L_pd33:
    v_mov_b32 v8, 163620
    v_mov_b32 v9, 1
    s_mov_b64 exec, 1
    ds_add_u32 v8, v9
    s_mov_b64 exec, -1
    s_branch L_kvgo
L_kvw:
    v_mov_b32 v8, 163620
    s_mov_b32 s16, 200000
L_lw34:
    ds_read_b32 v9, v8
    s_sub_u32 s16, s16, 1
    s_cbranch_scc1 L_ld35
    s_waitcnt lgkmcnt(0)
    v_cmp_gt_u32 vcc, 1, v9
    s_cbranch_vccnz L_lw34
L_ld35:
L_kvgo:
    buffer_load_dwordx4 v[204:207], v236, s[32:35], s60 offen sc1
    buffer_load_dwordx4 v[208:211], v236, s[32:35], s60 offen offset:16 sc1
    buffer_load_dwordx4 v[136:139], v14, s[32:35], s59 offen offset:0 sc1
    buffer_load_dwordx4 v[140:143], v14, s[32:35], s59 offen offset:1024 sc1
    buffer_load_dwordx4 v[144:147], v14, s[32:35], s59 offen offset:2048 sc1
    buffer_load_dwordx4 v[148:151], v14, s[32:35], s59 offen offset:3072 sc1
    s_add_u32 s59, s59, 4096
    buffer_load_dwordx4 v[152:155], v14, s[32:35], s59 offen offset:0 sc1
    buffer_load_dwordx4 v[156:159], v14, s[32:35], s59 offen offset:1024 sc1
    buffer_load_dwordx4 v[160:163], v14, s[32:35], s59 offen offset:2048 sc1
    buffer_load_dwordx4 v[164:167], v14, s[32:35], s59 offen offset:3072 sc1
    s_add_u32 s59, s59, 4096
    buffer_load_dwordx4 v[168:171], v14, s[32:35], s59 offen offset:0 sc1
    buffer_load_dwordx4 v[172:175], v14, s[32:35], s59 offen offset:1024 sc1
    buffer_load_dwordx4 v[176:179], v14, s[32:35], s59 offen offset:2048 sc1
    buffer_load_dwordx4 v[180:183], v14, s[32:35], s59 offen offset:3072 sc1
    s_add_u32 s59, s59, 4096
    buffer_load_dwordx4 v[184:187], v14, s[32:35], s59 offen offset:0 sc1
    buffer_load_dwordx4 v[188:191], v14, s[32:35], s59 offen offset:1024 sc1
    buffer_load_dwordx4 v[192:195], v14, s[32:35], s59 offen offset:2048 sc1
    buffer_load_dwordx4 v[196:199], v14, s[32:35], s59 offen offset:3072 sc1
    s_waitcnt vmcnt(16)
    v_add_f32_dpp v204, v204, v204 row_ror:8 row_mask:0xf bank_mask:0xf
    v_add_f32_dpp v205, v205, v205 row_ror:8 row_mask:0xf bank_mask:0xf
    v_add_f32_dpp v206, v206, v206 row_ror:8 row_mask:0xf bank_mask:0xf
    v_add_f32_dpp v207, v207, v207 row_ror:8 row_mask:0xf bank_mask:0xf
    v_add_f32_dpp v208, v208, v208 row_ror:8 row_mask:0xf bank_mask:0xf
    v_add_f32_dpp v209, v209, v209 row_ror:8 row_mask:0xf bank_mask:0xf
    v_add_f32_dpp v210, v210, v210 row_ror:8 row_mask:0xf bank_mask:0xf
    v_add_f32_dpp v211, v211, v211 row_ror:8 row_mask:0xf bank_mask:0xf
    v_add_f32_dpp v204, v204, v204 row_ror:4 row_mask:0xf bank_mask:0xf
    v_add_f32_dpp v205, v205, v205 row_ror:4 row_mask:0xf bank_mask:0xf
    v_add_f32_dpp v206, v206, v206 row_ror:4 row_mask:0xf bank_mask:0xf
    v_add_f32_dpp v207, v207, v207 row_ror:4 row_mask:0xf bank_mask:0xf
    v_add_f32_dpp v208, v208, v208 row_ror:4 row_mask:0xf bank_mask:0xf
    v_add_f32_dpp v209, v209, v209 row_ror:4 row_mask:0xf bank_mask:0xf
    v_add_f32_dpp v210, v210, v210 row_ror:4 row_mask:0xf bank_mask:0xf
    v_add_f32_dpp v211, v211, v211 row_ror:4 row_mask:0xf bank_mask:0xf
    v_add_f32_dpp v204, v204, v204 row_ror:2 row_mask:0xf bank_mask:0xf
    v_add_f32_dpp v205, v205, v205 row_ror:2 row_mask:0xf bank_mask:0xf
    v_add_f32_dpp v206, v206, v206 row_ror:2 row_mask:0xf bank_mask:0xf
    v_add_f32_dpp v207, v207, v207 row_ror:2 row_mask:0xf bank_mask:0xf
    v_add_f32_dpp v208, v208, v208 row_ror:2 row_mask:0xf bank_mask:0xf
    v_add_f32_dpp v209, v209, v209 row_ror:2 row_mask:0xf bank_mask:0xf
    v_add_f32_dpp v210, v210, v210 row_ror:2 row_mask:0xf bank_mask:0xf
    v_add_f32_dpp v211, v211, v211 row_ror:2 row_mask:0xf bank_mask:0xf
    v_add_f32_dpp v204, v204, v204 row_ror:1 row_mask:0xf bank_mask:0xf
    v_add_f32_dpp v205, v205, v205 row_ror:1 row_mask:0xf bank_mask:0xf
    v_add_f32_dpp v206, v206, v206 row_ror:1 row_mask:0xf bank_mask:0xf
    v_add_f32_dpp v207, v207, v207 row_ror:1 row_mask:0xf bank_mask:0xf
    v_add_f32_dpp v208, v208, v208 row_ror:1 row_mask:0xf bank_mask:0xf
    v_add_f32_dpp v209, v209, v209 row_ror:1 row_mask:0xf bank_mask:0xf
    v_add_f32_dpp v210, v210, v210 row_ror:1 row_mask:0xf bank_mask:0xf
    v_add_f32_dpp v211, v211, v211 row_ror:1 row_mask:0xf bank_mask:0xf
    v_cvt_pk_bf16_f32 v228, v204, v205
    v_cvt_pk_bf16_f32 v229, v206, v207
    v_cvt_pk_bf16_f32 v230, v208, v209
    v_cvt_pk_bf16_f32 v231, v210, v211
    s_nop 1
    v_mfma_f32_16x16x32_bf16 v[56:59], v[228:231], v[104:107], 0
    v_mfma_f32_16x16x32_bf16 v[60:63], v[228:231], v[108:111], 0
    v_mfma_f32_16x16x32_bf16 v[64:67], v[228:231], v[112:115], 0
    v_mfma_f32_16x16x32_bf16 v[68:71], v[228:231], v[116:119], 0
    v_mfma_f32_16x16x32_bf16 v[72:75], v[228:231], v[120:123], 0
    v_mfma_f32_16x16x32_bf16 v[76:79], v[228:231], v[124:127], 0
    v_mfma_f32_16x16x32_bf16 v[80:83], v[228:231], v[128:131], 0
    v_mfma_f32_16x16x32_bf16 v[84:87], v[228:231], v[132:135], 0
    s_waitcnt vmcnt(14)
    v_mov_b64 v[200:201], v[136:137]
    v_mfma_f32_16x16x32_bf16 v[220:223], v[232:235], v[138:141], 0
    s_waitcnt vmcnt(13)
    v_mfma_f32_16x16x32_bf16 v[216:219], v[232:235], v[142:145], 0
    s_waitcnt vmcnt(12)
    v_mfma_f32_16x16x32_bf16 v[220:223], v[232:235], v[146:149], v[220:223]
    s_waitcnt vmcnt(11)
    v_mfma_f32_16x16x32_bf16 v[216:219], v[232:235], v[150:153], v[216:219]
    s_waitcnt vmcnt(10)
    v_mfma_f32_16x16x32_bf16 v[220:223], v[232:235], v[154:157], v[220:223]
    v_add_f32 v56, s46, v56
    v_rcp_f32 v56, v56
    s_waitcnt vmcnt(9)
    v_mfma_f32_16x16x32_bf16 v[216:219], v[232:235], v[158:161], v[216:219]
L_hop18:
    s_cbranch_execz L_hopback
    v_add_f32 v60, s46, v60
    v_rcp_f32 v60, v60
    s_waitcnt vmcnt(8)
    v_mfma_f32_16x16x32_bf16 v[220:223], v[232:235], v[162:165], v[220:223]
    v_add_f32 v64, s46, v64
    v_rcp_f32 v64, v64
    s_waitcnt vmcnt(7)
    v_mfma_f32_16x16x32_bf16 v[216:219], v[232:235], v[166:169], v[216:219]
    v_add_f32 v68, s46, v68
    v_rcp_f32 v68, v68
    s_waitcnt vmcnt(6)
    v_mfma_f32_16x16x32_bf16 v[220:223], v[232:235], v[170:173], v[220:223]
    v_add_f32 v72, s46, v72
    v_rcp_f32 v72, v72
    s_waitcnt vmcnt(5)
    v_mfma_f32_16x16x32_bf16 v[216:219], v[232:235], v[174:177], v[216:219]
    v_add_f32 v76, s46, v76
    v_rcp_f32 v76, v76
    s_waitcnt vmcnt(4)
    v_mfma_f32_16x16x32_bf16 v[220:223], v[232:235], v[178:181], v[220:223]
    v_add_f32 v80, s46, v80
    v_rcp_f32 v80, v80
    s_waitcnt vmcnt(3)
    v_mfma_f32_16x16x32_bf16 v[216:219], v[232:235], v[182:185], v[216:219]
    v_add_f32 v84, s46, v84
    v_rcp_f32 v84, v84
    s_waitcnt vmcnt(2)
    v_mfma_f32_16x16x32_bf16 v[220:223], v[232:235], v[186:189], v[220:223]
    s_waitcnt vmcnt(1)
    v_mfma_f32_16x16x32_bf16 v[216:219], v[232:235], v[190:193], v[216:219]
    s_waitcnt vmcnt(0)
    v_mfma_f32_16x16x32_bf16 v[220:223], v[232:235], v[194:197], v[220:223]
    s_waitcnt vmcnt(0)
    v_mfma_f32_16x16x32_bf16 v[216:219], v[232:235], v[198:201], v[216:219]
    s_nop 7
    v_cvt_pk_bf16_f32 v224, v216, v217
    v_cvt_pk_bf16_f32 v225, v218, v219
    v_cvt_pk_bf16_f32 v226, v220, v221
    v_cvt_pk_bf16_f32 v227, v222, v223
    s_nop 1
    v_mfma_f32_16x16x32_bf16 v[24:27], v[224:227], v[104:107], 0
    v_mfma_f32_16x16x32_bf16 v[28:31], v[224:227], v[108:111], 0
    v_mfma_f32_16x16x32_bf16 v[32:35], v[224:227], v[112:115], 0
    v_mfma_f32_16x16x32_bf16 v[36:39], v[224:227], v[116:119], 0
    v_mfma_f32_16x16x32_bf16 v[40:43], v[224:227], v[120:123], 0
    v_mfma_f32_16x16x32_bf16 v[44:47], v[224:227], v[124:127], 0
    v_mfma_f32_16x16x32_bf16 v[48:51], v[224:227], v[128:131], 0
    v_mfma_f32_16x16x32_bf16 v[52:55], v[224:227], v[132:135], 0
    s_nop 0
    v_mul_f32 v24, v24, v56
    v_mul_f32 v25, v25, v56
    v_mul_f32 v26, v26, v56
    v_mul_f32 v27, v27, v56
    v_cvt_pk_bf16_f32 v152, v24, v25
    v_cvt_pk_bf16_f32 v153, v26, v27
    v_mul_f32 v28, v28, v60
    v_mul_f32 v29, v29, v60
    v_mul_f32 v30, v30, v60
    v_mul_f32 v31, v31, v60
    v_cvt_pk_bf16_f32 v154, v28, v29
    v_cvt_pk_bf16_f32 v155, v30, v31
    s_nop 0
    v_permlane16_swap_b32 v152, v154
    v_permlane16_swap_b32 v153, v155
    buffer_store_dwordx4 v[152:155], v237, s[32:35], s62 offen sc1
    s_add_u32 s62, s62, 65536
    v_mul_f32 v32, v32, v64
    v_mul_f32 v33, v33, v64
    v_mul_f32 v34, v34, v64
    v_mul_f32 v35, v35, v64
    v_cvt_pk_bf16_f32 v156, v32, v33
    v_cvt_pk_bf16_f32 v157, v34, v35
    v_mul_f32 v36, v36, v68
    v_mul_f32 v37, v37, v68
    v_mul_f32 v38, v38, v68
    v_mul_f32 v39, v39, v68
    v_cvt_pk_bf16_f32 v158, v36, v37
    v_cvt_pk_bf16_f32 v159, v38, v39
    s_nop 0
    v_permlane16_swap_b32 v156, v158
    v_permlane16_swap_b32 v157, v159
    buffer_store_dwordx4 v[156:159], v237, s[32:35], s62 offen sc1
    s_add_u32 s62, s62, 65536
    v_mul_f32 v40, v40, v72
    v_mul_f32 v41, v41, v72
    v_mul_f32 v42, v42, v72
    v_mul_f32 v43, v43, v72
    v_cvt_pk_bf16_f32 v160, v40, v41
    v_cvt_pk_bf16_f32 v161, v42, v43
    v_mul_f32 v44, v44, v76
    v_mul_f32 v45, v45, v76
    v_mul_f32 v46, v46, v76
    v_mul_f32 v47, v47, v76
    v_cvt_pk_bf16_f32 v162, v44, v45
    v_cvt_pk_bf16_f32 v163, v46, v47
    s_nop 0
    v_permlane16_swap_b32 v160, v162
    v_permlane16_swap_b32 v161, v163
    buffer_store_dwordx4 v[160:163], v237, s[32:35], s62 offen sc1
    s_add_u32 s62, s62, 65536
    v_mul_f32 v48, v48, v80
    v_mul_f32 v49, v49, v80
    v_mul_f32 v50, v50, v80
    v_mul_f32 v51, v51, v80
    v_cvt_pk_bf16_f32 v164, v48, v49
    v_cvt_pk_bf16_f32 v165, v50, v51
    v_mul_f32 v52, v52, v84
    v_mul_f32 v53, v53, v84
    v_mul_f32 v54, v54, v84
    v_mul_f32 v55, v55, v84
    v_cvt_pk_bf16_f32 v166, v52, v53
    v_cvt_pk_bf16_f32 v167, v54, v55
    s_nop 0
    v_permlane16_swap_b32 v164, v166
    v_permlane16_swap_b32 v165, v167
    buffer_store_dwordx4 v[164:167], v237, s[32:35], s62 offen sc1
    v_mov_b64 v[120:121], 0
    v_mov_b64 v[122:123], 0
    v_mov_b64 v[124:125], 0
    v_mov_b64 v[126:127], 0
    v_mov_b64 v[128:129], 0
    v_mov_b64 v[130:131], 0
    v_mov_b64 v[132:133], 0
    v_mov_b64 v[134:135], 0
    v_mov_b64 v[136:137], 0
    v_mov_b64 v[138:139], 0
    v_mov_b64 v[140:141], 0
    v_mov_b64 v[142:143], 0
    v_mov_b64 v[144:145], 0
    v_mov_b64 v[146:147], 0
    v_mov_b64 v[148:149], 0
    v_mov_b64 v[150:151], 0
    s_add_u32 s44, s17, s99
    v_mov_b32 v8, 163608
    s_mov_b32 s16, 200000
L_lw36:
    ds_read_b32 v9, v8
    s_sub_u32 s16, s16, 1
    s_cbranch_scc1 L_ld37
    s_waitcnt lgkmcnt(0)
    v_cmp_gt_u32 vcc, 4, v9
    s_cbranch_vccnz L_lw36
L_ld37:
    s_waitcnt vmcnt(0)
    v_mov_b32 v8, 163596
    v_mov_b32 v9, 1
    s_mov_b64 exec, 1
    ds_add_rtn_u32 v9, v8, v9
    s_mov_b64 exec, -1
    s_waitcnt lgkmcnt(0)
    v_readfirstlane_b32 s42, v9
    s_nop 0
    s_cmp_eq_u32 s42, 3
    s_cbranch_scc0 L_noof
    v_lshlrev_b32 v6, 26, v2
    v_mov_b32 v7, s54
    buffer_store_dword v7, v6, s[32:35], s63 offen sc1
L_noof:
    v_mov_b32 v8, 163596
    s_mov_b32 s16, 200000
L_lw38:
    ds_read_b32 v9, v8
    s_sub_u32 s16, s16, 1
    s_cbranch_scc1 L_ld39
    s_waitcnt lgkmcnt(0)
    v_cmp_gt_u32 vcc, 4, v9
    s_cbranch_vccnz L_lw38
L_ld39:
    s_lshl_b32 s45, s22, 13
    s_add_u32 m0, s45, 0
    s_lshl_b32 s45, s98, 1
    s_add_u32 s45, s45, s22
    s_add_u32 s45, s45, 12
    s_and_b32 s45, s45, 15
    s_lshl_b32 s45, s45, 17
    buffer_load_dwordx4 v238, s[36:39], s45 offen lds
    s_add_u32 m0, m0, 1024
    s_nop 0
    buffer_load_dwordx4 v239, s[36:39], s45 offen lds
    s_add_u32 m0, m0, 1024
    s_add_u32 s45, s45, 32768
    buffer_load_dwordx4 v238, s[36:39], s45 offen lds
    s_add_u32 m0, m0, 1024
    s_nop 0
    buffer_load_dwordx4 v239, s[36:39], s45 offen lds
    s_add_u32 m0, m0, 1024
    s_add_u32 s45, s45, 32768
    buffer_load_dwordx4 v238, s[36:39], s45 offen lds
    s_add_u32 m0, m0, 1024
    s_nop 0
    buffer_load_dwordx4 v239, s[36:39], s45 offen lds
    s_add_u32 m0, m0, 1024
L_hop19:
    s_cbranch_execz L_hopback
    s_add_u32 s45, s45, 32768
    buffer_load_dwordx4 v238, s[36:39], s45 offen lds
    s_add_u32 m0, m0, 1024
    s_nop 0
    buffer_load_dwordx4 v239, s[36:39], s45 offen lds
    s_cmp_eq_u32 s42, 0
    s_cbranch_scc0 L_ow
    s_mov_b32 s16, 200000
L_pg40:
    buffer_load_dword v7, v251, s[32:35], s55 offen sc1
    s_sub_u32 s16, s16, 1
    s_cbranch_scc1 L_pd41
    s_waitcnt vmcnt(0)
    v_cmp_ne_u32 vcc, s54, v7
    s_cbranch_vccnz L_pg40
L_pd41:
    v_mov_b32 v8, 163624
    v_mov_b32 v9, 1
    s_mov_b64 exec, 1
    ds_add_u32 v8, v9
    s_mov_b64 exec, -1
    s_branch L_ogo
L_ow:
    v_mov_b32 v8, 163624
    s_mov_b32 s16, 200000
L_lw42:
    ds_read_b32 v9, v8
    s_sub_u32 s16, s16, 1
    s_cbranch_scc1 L_ld43
    s_waitcnt lgkmcnt(0)
    v_cmp_gt_u32 vcc, 1, v9
    s_cbranch_vccnz L_lw42
L_ld43:
L_ogo:
    buffer_load_dwordx4 v[24:27], v237, s[32:35], s44 offen offset:0 sc1
    buffer_load_dwordx4 v[28:31], v237, s[32:35], s44 offen offset:512 sc1
    buffer_load_dwordx4 v[32:35], v237, s[32:35], s44 offen offset:1024 sc1
    buffer_load_dwordx4 v[36:39], v237, s[32:35], s44 offen offset:1536 sc1
    buffer_load_dwordx4 v[40:43], v237, s[32:35], s44 offen offset:2048 sc1
    buffer_load_dwordx4 v[44:47], v237, s[32:35], s44 offen offset:2560 sc1
    buffer_load_dwordx4 v[48:51], v237, s[32:35], s44 offen offset:3072 sc1
    buffer_load_dwordx4 v[52:55], v237, s[32:35], s44 offen offset:3584 sc1
    s_add_u32 s99, s99, 4096
    s_and_b32 s99, s99, 32767
    s_add_u32 s44, s17, s99
    buffer_load_dwordx4 v[56:59], v237, s[32:35], s44 offen offset:0 sc1
    buffer_load_dwordx4 v[60:63], v237, s[32:35], s44 offen offset:512 sc1
    buffer_load_dwordx4 v[64:67], v237, s[32:35], s44 offen offset:1024 sc1
    buffer_load_dwordx4 v[68:71], v237, s[32:35], s44 offen offset:1536 sc1
    buffer_load_dwordx4 v[72:75], v237, s[32:35], s44 offen offset:2048 sc1
    buffer_load_dwordx4 v[76:79], v237, s[32:35], s44 offen offset:2560 sc1
    buffer_load_dwordx4 v[80:83], v237, s[32:35], s44 offen offset:3072 sc1
    buffer_load_dwordx4 v[84:87], v237, s[32:35], s44 offen offset:3584 sc1
    s_add_u32 s99, s99, 4096
    s_and_b32 s99, s99, 32767
    s_add_u32 s44, s17, s99
    s_waitcnt vmcnt(16)
    v_mov_b32 v8, 163628
    v_mov_b32 v9, 1
    s_mov_b64 exec, 1
    ds_add_u32 v8, v9
    s_mov_b64 exec, -1
    ds_read_b64_tr_b16 v[88:89], v244 offset:0
    ds_read_b64_tr_b16 v[90:91], v244 offset:512
    ds_read_b64_tr_b16 v[92:93], v245 offset:0
    ds_read_b64_tr_b16 v[94:95], v245 offset:512
    ds_read_b64_tr_b16 v[100:101], v245 offset:2048
    ds_read_b64_tr_b16 v[102:103], v245 offset:2560
    ds_read_b64_tr_b16 v[96:97], v244 offset:2048
    ds_read_b64_tr_b16 v[98:99], v244 offset:2560
    s_mov_b32 s43, 0
    s_mov_b32 s42, 4294885376
L_oloop:
    s_waitcnt vmcnt(15) lgkmcnt(6)
    v_mfma_f32_32x32x16_bf16 v[120:135], v[88:91], v[24:27], v[120:135]
    ds_read_b64_tr_b16 v[104:105], v244 offset:4096
    ds_read_b64_tr_b16 v[106:107], v244 offset:4608
    s_waitcnt lgkmcnt(6)
    v_mfma_f32_32x32x16_bf16 v[136:151], v[92:95], v[24:27], v[136:151]
    ds_read_b64_tr_b16 v[108:109], v245 offset:4096
    ds_read_b64_tr_b16 v[110:111], v245 offset:4608
    buffer_load_dwordx4 v[24:27], v237, s[32:35], s44 offen offset:0 sc1
    s_waitcnt vmcnt(15) lgkmcnt(6)
    v_mfma_f32_32x32x16_bf16 v[136:151], v[100:103], v[28:31], v[136:151]
    ds_read_b64_tr_b16 v[116:117], v245 offset:6144
    ds_read_b64_tr_b16 v[118:119], v245 offset:6656
    s_waitcnt lgkmcnt(6)
    v_mfma_f32_32x32x16_bf16 v[120:135], v[96:99], v[28:31], v[120:135]
    ds_read_b64_tr_b16 v[112:113], v244 offset:6144
    ds_read_b64_tr_b16 v[114:115], v244 offset:6656
    buffer_load_dwordx4 v[28:31], v237, s[32:35], s44 offen offset:512 sc1
    s_waitcnt vmcnt(15) lgkmcnt(6)
    v_mfma_f32_32x32x16_bf16 v[120:135], v[104:107], v[32:35], v[120:135]
    ds_read_b64_tr_b16 v[88:89], v244 offset:8192
    ds_read_b64_tr_b16 v[90:91], v244 offset:8704
    s_waitcnt lgkmcnt(6)
    v_mfma_f32_32x32x16_bf16 v[136:151], v[108:111], v[32:35], v[136:151]
    ds_read_b64_tr_b16 v[92:93], v245 offset:8192
    ds_read_b64_tr_b16 v[94:95], v245 offset:8704
    buffer_load_dwordx4 v[32:35], v237, s[32:35], s44 offen offset:1024 sc1
    s_waitcnt vmcnt(15) lgkmcnt(6)
    v_mfma_f32_32x32x16_bf16 v[136:151], v[116:119], v[36:39], v[136:151]
    ds_read_b64_tr_b16 v[100:101], v245 offset:10240
    ds_read_b64_tr_b16 v[102:103], v245 offset:10752
    s_waitcnt lgkmcnt(6)
    v_mfma_f32_32x32x16_bf16 v[120:135], v[112:115], v[36:39], v[120:135]
    ds_read_b64_tr_b16 v[96:97], v244 offset:10240
    ds_read_b64_tr_b16 v[98:99], v244 offset:10752
    buffer_load_dwordx4 v[36:39], v237, s[32:35], s44 offen offset:1536 sc1
    s_waitcnt vmcnt(15) lgkmcnt(6)
    v_mfma_f32_32x32x16_bf16 v[120:135], v[88:91], v[40:43], v[120:135]
    ds_read_b64_tr_b16 v[104:105], v244 offset:12288
    ds_read_b64_tr_b16 v[106:107], v244 offset:12800
    s_waitcnt lgkmcnt(6)
    v_mfma_f32_32x32x16_bf16 v[136:151], v[92:95], v[40:43], v[136:151]
    ds_read_b64_tr_b16 v[108:109], v245 offset:12288
    ds_read_b64_tr_b16 v[110:111], v245 offset:12800
    buffer_load_dwordx4 v[40:43], v237, s[32:35], s44 offen offset:2048 sc1
    s_waitcnt vmcnt(15) lgkmcnt(6)
    v_mfma_f32_32x32x16_bf16 v[136:151], v[100:103], v[44:47], v[136:151]
    ds_read_b64_tr_b16 v[116:117], v245 offset:14336
    ds_read_b64_tr_b16 v[118:119], v245 offset:14848
    s_waitcnt lgkmcnt(6)
    v_mfma_f32_32x32x16_bf16 v[120:135], v[96:99], v[44:47], v[120:135]
    ds_read_b64_tr_b16 v[112:113], v244 offset:14336
    ds_read_b64_tr_b16 v[114:115], v244 offset:14848
    buffer_load_dwordx4 v[44:47], v237, s[32:35], s44 offen offset:2560 sc1
    s_waitcnt vmcnt(15) lgkmcnt(6)
    v_mfma_f32_32x32x16_bf16 v[120:135], v[104:107], v[48:51], v[120:135]
    ds_read_b64_tr_b16 v[88:89], v244 offset:16384
    ds_read_b64_tr_b16 v[90:91], v244 offset:16896
    s_cmp_eq_u32 s43, 2
    s_cbranch_scc0 L_nos13
    v_mov_b32 v8, 163636
    v_mov_b32 v9, 1
    s_mov_b64 exec, 1
    ds_add_u32 v8, v9
    s_mov_b64 exec, -1
L_nos13:
    s_waitcnt lgkmcnt(6)
    v_mfma_f32_32x32x16_bf16 v[136:151], v[108:111], v[48:51], v[136:151]
    ds_read_b64_tr_b16 v[92:93], v245 offset:16384
    ds_read_b64_tr_b16 v[94:95], v245 offset:16896
    buffer_load_dwordx4 v[48:51], v237, s[32:35], s44 offen offset:3072 sc1
    s_waitcnt vmcnt(15) lgkmcnt(6)
    v_mfma_f32_32x32x16_bf16 v[136:151], v[116:119], v[52:55], v[136:151]
    ds_read_b64_tr_b16 v[100:101], v245 offset:18432
    ds_read_b64_tr_b16 v[102:103], v245 offset:18944
    s_waitcnt lgkmcnt(6)
    v_mfma_f32_32x32x16_bf16 v[120:135], v[112:115], v[52:55], v[120:135]
    ds_read_b64_tr_b16 v[96:97], v244 offset:18432
    ds_read_b64_tr_b16 v[98:99], v244 offset:18944
    buffer_load_dwordx4 v[52:55], v237, s[32:35], s44 offen offset:3584 sc1
    s_add_u32 s99, s99, 4096
    s_and_b32 s99, s99, 32767
    s_add_u32 s44, s17, s99
    s_waitcnt vmcnt(15) lgkmcnt(6)
    v_mfma_f32_32x32x16_bf16 v[120:135], v[88:91], v[56:59], v[120:135]
    ds_read_b64_tr_b16 v[104:105], v244 offset:20480
L_hop20:
    s_cbranch_execz L_hopback
    ds_read_b64_tr_b16 v[106:107], v244 offset:20992
    s_waitcnt lgkmcnt(6)
    v_mfma_f32_32x32x16_bf16 v[136:151], v[92:95], v[56:59], v[136:151]
    ds_read_b64_tr_b16 v[108:109], v245 offset:20480
    ds_read_b64_tr_b16 v[110:111], v245 offset:20992
    buffer_load_dwordx4 v[56:59], v237, s[32:35], s44 offen offset:0 sc1
    s_waitcnt vmcnt(15) lgkmcnt(6)
    v_mfma_f32_32x32x16_bf16 v[136:151], v[100:103], v[60:63], v[136:151]
    ds_read_b64_tr_b16 v[116:117], v245 offset:22528
    ds_read_b64_tr_b16 v[118:119], v245 offset:23040
    s_waitcnt lgkmcnt(6)
    v_mfma_f32_32x32x16_bf16 v[120:135], v[96:99], v[60:63], v[120:135]
    ds_read_b64_tr_b16 v[112:113], v244 offset:22528
    ds_read_b64_tr_b16 v[114:115], v244 offset:23040
    buffer_load_dwordx4 v[60:63], v237, s[32:35], s44 offen offset:512 sc1
    s_waitcnt vmcnt(15) lgkmcnt(6)
    v_mfma_f32_32x32x16_bf16 v[120:135], v[104:107], v[64:67], v[120:135]
    ds_read_b64_tr_b16 v[88:89], v244 offset:24576
    ds_read_b64_tr_b16 v[90:91], v244 offset:25088
    s_waitcnt lgkmcnt(6)
    v_mfma_f32_32x32x16_bf16 v[136:151], v[108:111], v[64:67], v[136:151]
    ds_read_b64_tr_b16 v[92:93], v245 offset:24576
    ds_read_b64_tr_b16 v[94:95], v245 offset:25088
    buffer_load_dwordx4 v[64:67], v237, s[32:35], s44 offen offset:1024 sc1
    s_waitcnt vmcnt(15) lgkmcnt(6)
    v_mfma_f32_32x32x16_bf16 v[136:151], v[116:119], v[68:71], v[136:151]
    ds_read_b64_tr_b16 v[100:101], v245 offset:26624
    ds_read_b64_tr_b16 v[102:103], v245 offset:27136
    s_waitcnt lgkmcnt(6)
    v_mfma_f32_32x32x16_bf16 v[120:135], v[112:115], v[68:71], v[120:135]
    ds_read_b64_tr_b16 v[96:97], v244 offset:26624
    ds_read_b64_tr_b16 v[98:99], v244 offset:27136
    buffer_load_dwordx4 v[68:71], v237, s[32:35], s44 offen offset:1536 sc1
    s_waitcnt vmcnt(15) lgkmcnt(6)
    v_mfma_f32_32x32x16_bf16 v[120:135], v[88:91], v[72:75], v[120:135]
    ds_read_b64_tr_b16 v[104:105], v244 offset:28672
    ds_read_b64_tr_b16 v[106:107], v244 offset:29184
    s_waitcnt lgkmcnt(6)
    v_mfma_f32_32x32x16_bf16 v[136:151], v[92:95], v[72:75], v[136:151]
    ds_read_b64_tr_b16 v[108:109], v245 offset:28672
    ds_read_b64_tr_b16 v[110:111], v245 offset:29184
    buffer_load_dwordx4 v[72:75], v237, s[32:35], s44 offen offset:2048 sc1
    s_waitcnt vmcnt(15) lgkmcnt(6)
    v_mfma_f32_32x32x16_bf16 v[136:151], v[100:103], v[76:79], v[136:151]
    ds_read_b64_tr_b16 v[116:117], v245 offset:30720
    ds_read_b64_tr_b16 v[118:119], v245 offset:31232
    s_waitcnt lgkmcnt(6)
    v_mfma_f32_32x32x16_bf16 v[120:135], v[96:99], v[76:79], v[120:135]
    ds_read_b64_tr_b16 v[112:113], v244 offset:30720
    ds_read_b64_tr_b16 v[114:115], v244 offset:31232
    buffer_load_dwordx4 v[76:79], v237, s[32:35], s44 offen offset:2560 sc1
    s_waitcnt vmcnt(15) lgkmcnt(6)
    s_cmp_eq_u32 s43, 2
    s_cbranch_scc0 L_noc3
    v_mov_b32 v8, 163628
    s_mov_b32 s16, 200000
L_lw44:
    ds_read_b32 v9, v8
    s_sub_u32 s16, s16, 1
    s_cbranch_scc1 L_ld45
    s_waitcnt lgkmcnt(0)
    v_cmp_gt_u32 vcc, 4, v9
    s_cbranch_vccnz L_lw44
L_ld45:
L_noc3:
    v_add_u32 v244, s42, v244
    v_add_u32 v245, s42, v245
    v_mfma_f32_32x32x16_bf16 v[120:135], v[104:107], v[80:83], v[120:135]
    ds_read_b64_tr_b16 v[88:89], v244 offset:0
    ds_read_b64_tr_b16 v[90:91], v244 offset:512
    s_waitcnt lgkmcnt(6)
    v_mfma_f32_32x32x16_bf16 v[136:151], v[108:111], v[80:83], v[136:151]
    ds_read_b64_tr_b16 v[92:93], v245 offset:0
    ds_read_b64_tr_b16 v[94:95], v245 offset:512
    buffer_load_dwordx4 v[80:83], v237, s[32:35], s44 offen offset:3072 sc1
    s_waitcnt vmcnt(15) lgkmcnt(6)
    v_mfma_f32_32x32x16_bf16 v[136:151], v[116:119], v[84:87], v[136:151]
    ds_read_b64_tr_b16 v[100:101], v245 offset:2048
    ds_read_b64_tr_b16 v[102:103], v245 offset:2560
    s_waitcnt lgkmcnt(6)
    v_mfma_f32_32x32x16_bf16 v[120:135], v[112:115], v[84:87], v[120:135]
    ds_read_b64_tr_b16 v[96:97], v244 offset:2048
    ds_read_b64_tr_b16 v[98:99], v244 offset:2560
    buffer_load_dwordx4 v[84:87], v237, s[32:35], s44 offen offset:3584 sc1
    s_add_u32 s99, s99, 4096
    s_and_b32 s99, s99, 32767
    s_add_u32 s44, s17, s99
    s_add_u32 s43, s43, 1
    s_cmp_eq_u32 s43, 1
    s_mov_b32 s42, 4294891520
    s_cselect_b32 s42, 40960, s42
    s_cmp_lt_u32 s43, 3
    s_cbranch_scc1 L_oloop
    s_waitcnt vmcnt(15) lgkmcnt(6)
    v_mfma_f32_32x32x16_bf16 v[120:135], v[88:91], v[24:27], v[120:135]
    ds_read_b64_tr_b16 v[104:105], v244 offset:4096
    ds_read_b64_tr_b16 v[106:107], v244 offset:4608
    s_waitcnt lgkmcnt(6)
    v_mfma_f32_32x32x16_bf16 v[136:151], v[92:95], v[24:27], v[136:151]
    ds_read_b64_tr_b16 v[108:109], v245 offset:4096
    ds_read_b64_tr_b16 v[110:111], v245 offset:4608
    s_waitcnt vmcnt(14) lgkmcnt(6)
    v_mfma_f32_32x32x16_bf16 v[136:151], v[100:103], v[28:31], v[136:151]
    ds_read_b64_tr_b16 v[116:117], v245 offset:6144
    ds_read_b64_tr_b16 v[118:119], v245 offset:6656
    s_waitcnt lgkmcnt(6)
    v_mfma_f32_32x32x16_bf16 v[120:135], v[96:99], v[28:31], v[120:135]
    ds_read_b64_tr_b16 v[112:113], v244 offset:6144
    ds_read_b64_tr_b16 v[114:115], v244 offset:6656
    s_waitcnt vmcnt(13) lgkmcnt(6)
    v_mfma_f32_32x32x16_bf16 v[120:135], v[104:107], v[32:35], v[120:135]
    ds_read_b64_tr_b16 v[88:89], v244 offset:8192
    ds_read_b64_tr_b16 v[90:91], v244 offset:8704
    v_mov_b32 v8, 163612
    s_mov_b32 s16, 200000
L_lw46:
    ds_read_b32 v9, v8
    s_sub_u32 s16, s16, 1
    s_cbranch_scc1 L_ld47
    s_waitcnt lgkmcnt(0)
    v_cmp_gt_u32 vcc, 4, v9
    s_cbranch_vccnz L_lw46
L_ld47:
    buffer_load_dword v184, v246, s[32:35], s65 offen sc1
    s_waitcnt lgkmcnt(6)
    v_mfma_f32_32x32x16_bf16 v[136:151], v[108:111], v[32:35], v[136:151]
    ds_read_b64_tr_b16 v[92:93], v245 offset:8192
    ds_read_b64_tr_b16 v[94:95], v245 offset:8704
    buffer_load_dwordx4 v[152:155], v247, s[32:35], s64 offen sc1
    s_add_u32 s64, s64, 32768
    s_waitcnt vmcnt(14) lgkmcnt(6)
    v_mfma_f32_32x32x16_bf16 v[136:151], v[116:119], v[36:39], v[136:151]
    ds_read_b64_tr_b16 v[100:101], v245 offset:10240
    ds_read_b64_tr_b16 v[102:103], v245 offset:10752
    buffer_load_dwordx4 v[156:159], v247, s[32:35], s64 offen sc1
    s_add_u32 s64, s64, 32768
    s_waitcnt lgkmcnt(6)
    v_mfma_f32_32x32x16_bf16 v[120:135], v[112:115], v[36:39], v[120:135]
    ds_read_b64_tr_b16 v[96:97], v244 offset:10240
    ds_read_b64_tr_b16 v[98:99], v244 offset:10752
    buffer_load_dwordx4 v[160:163], v247, s[32:35], s64 offen sc1
    s_add_u32 s64, s64, 32768
    s_waitcnt vmcnt(15) lgkmcnt(6)
    v_mfma_f32_32x32x16_bf16 v[120:135], v[88:91], v[40:43], v[120:135]
    ds_read_b64_tr_b16 v[104:105], v244 offset:12288
    ds_read_b64_tr_b16 v[106:107], v244 offset:12800
    buffer_load_dwordx4 v[164:167], v247, s[32:35], s64 offen sc1
    s_add_u32 s64, s64, 32768
    s_waitcnt lgkmcnt(6)
    v_mfma_f32_32x32x16_bf16 v[136:151], v[92:95], v[40:43], v[136:151]
    ds_read_b64_tr_b16 v[108:109], v245 offset:12288
    ds_read_b64_tr_b16 v[110:111], v245 offset:12800
    buffer_load_dwordx4 v[168:171], v247, s[32:35], s64 offen sc1
    s_add_u32 s64, s64, 32768
    s_waitcnt vmcnt(16) lgkmcnt(6)
L_hop21:
    s_cbranch_execz L_hopback
    v_mfma_f32_32x32x16_bf16 v[136:151], v[100:103], v[44:47], v[136:151]
    ds_read_b64_tr_b16 v[116:117], v245 offset:14336
    ds_read_b64_tr_b16 v[118:119], v245 offset:14848
    buffer_load_dwordx4 v[172:175], v247, s[32:35], s64 offen sc1
    s_add_u32 s64, s64, 32768
    s_waitcnt lgkmcnt(6)
    v_mfma_f32_32x32x16_bf16 v[120:135], v[96:99], v[44:47], v[120:135]
    ds_read_b64_tr_b16 v[112:113], v244 offset:14336
    ds_read_b64_tr_b16 v[114:115], v244 offset:14848
    buffer_load_dwordx4 v[176:179], v247, s[32:35], s64 offen sc1
    s_add_u32 s64, s64, 32768
    s_waitcnt vmcnt(17) lgkmcnt(6)
    v_mfma_f32_32x32x16_bf16 v[120:135], v[104:107], v[48:51], v[120:135]
    ds_read_b64_tr_b16 v[88:89], v244 offset:16384
    ds_read_b64_tr_b16 v[90:91], v244 offset:16896
    buffer_load_dwordx4 v[180:183], v247, s[32:35], s64 offen sc1
    s_waitcnt lgkmcnt(6)
    v_mfma_f32_32x32x16_bf16 v[136:151], v[108:111], v[48:51], v[136:151]
    ds_read_b64_tr_b16 v[92:93], v245 offset:16384
    ds_read_b64_tr_b16 v[94:95], v245 offset:16896
    s_waitcnt vmcnt(17) lgkmcnt(6)
    v_mfma_f32_32x32x16_bf16 v[136:151], v[116:119], v[52:55], v[136:151]
    ds_read_b64_tr_b16 v[100:101], v245 offset:18432
    ds_read_b64_tr_b16 v[102:103], v245 offset:18944
    s_waitcnt lgkmcnt(6)
    v_mfma_f32_32x32x16_bf16 v[120:135], v[112:115], v[52:55], v[120:135]
    ds_read_b64_tr_b16 v[96:97], v244 offset:18432
    ds_read_b64_tr_b16 v[98:99], v244 offset:18944
    s_waitcnt vmcnt(16) lgkmcnt(6)
    v_mfma_f32_32x32x16_bf16 v[120:135], v[88:91], v[56:59], v[120:135]
    ds_read_b64_tr_b16 v[104:105], v244 offset:20480
    ds_read_b64_tr_b16 v[106:107], v244 offset:20992
    s_waitcnt lgkmcnt(6)
    v_mfma_f32_32x32x16_bf16 v[136:151], v[92:95], v[56:59], v[136:151]
    ds_read_b64_tr_b16 v[108:109], v245 offset:20480
    ds_read_b64_tr_b16 v[110:111], v245 offset:20992
    s_waitcnt vmcnt(15) lgkmcnt(6)
    v_mfma_f32_32x32x16_bf16 v[136:151], v[100:103], v[60:63], v[136:151]
    ds_read_b64_tr_b16 v[116:117], v245 offset:22528
    ds_read_b64_tr_b16 v[118:119], v245 offset:23040
    s_waitcnt lgkmcnt(6)
    v_mfma_f32_32x32x16_bf16 v[120:135], v[96:99], v[60:63], v[120:135]
    ds_read_b64_tr_b16 v[112:113], v244 offset:22528
    ds_read_b64_tr_b16 v[114:115], v244 offset:23040
    s_waitcnt vmcnt(14) lgkmcnt(6)
    v_mfma_f32_32x32x16_bf16 v[120:135], v[104:107], v[64:67], v[120:135]
    ds_read_b64_tr_b16 v[88:89], v244 offset:24576
    ds_read_b64_tr_b16 v[90:91], v244 offset:25088
    s_waitcnt lgkmcnt(6)
    v_mfma_f32_32x32x16_bf16 v[136:151], v[108:111], v[64:67], v[136:151]
    ds_read_b64_tr_b16 v[92:93], v245 offset:24576
    ds_read_b64_tr_b16 v[94:95], v245 offset:25088
    s_waitcnt vmcnt(13) lgkmcnt(6)
    v_mfma_f32_32x32x16_bf16 v[136:151], v[116:119], v[68:71], v[136:151]
    ds_read_b64_tr_b16 v[100:101], v245 offset:26624
    ds_read_b64_tr_b16 v[102:103], v245 offset:27136
    s_waitcnt lgkmcnt(6)
    v_mfma_f32_32x32x16_bf16 v[120:135], v[112:115], v[68:71], v[120:135]
    ds_read_b64_tr_b16 v[96:97], v244 offset:26624
    ds_read_b64_tr_b16 v[98:99], v244 offset:27136
    s_waitcnt vmcnt(12) lgkmcnt(6)
    v_mfma_f32_32x32x16_bf16 v[120:135], v[88:91], v[72:75], v[120:135]
    ds_read_b64_tr_b16 v[104:105], v244 offset:28672
    ds_read_b64_tr_b16 v[106:107], v244 offset:29184
    s_waitcnt lgkmcnt(6)
    v_mfma_f32_32x32x16_bf16 v[136:151], v[92:95], v[72:75], v[136:151]
    ds_read_b64_tr_b16 v[108:109], v245 offset:28672
    ds_read_b64_tr_b16 v[110:111], v245 offset:29184
    s_waitcnt vmcnt(11) lgkmcnt(6)
    v_mfma_f32_32x32x16_bf16 v[136:151], v[100:103], v[76:79], v[136:151]
    ds_read_b64_tr_b16 v[116:117], v245 offset:30720
    ds_read_b64_tr_b16 v[118:119], v245 offset:31232
    s_waitcnt lgkmcnt(6)
    v_mfma_f32_32x32x16_bf16 v[120:135], v[96:99], v[76:79], v[120:135]
    ds_read_b64_tr_b16 v[112:113], v244 offset:30720
    ds_read_b64_tr_b16 v[114:115], v244 offset:31232
    s_waitcnt vmcnt(10) lgkmcnt(6)
    v_mfma_f32_32x32x16_bf16 v[120:135], v[104:107], v[80:83], v[120:135]
    s_waitcnt lgkmcnt(4)
    v_mfma_f32_32x32x16_bf16 v[136:151], v[108:111], v[80:83], v[136:151]
    s_waitcnt vmcnt(9) lgkmcnt(2)
    v_mfma_f32_32x32x16_bf16 v[136:151], v[116:119], v[84:87], v[136:151]
    s_waitcnt lgkmcnt(0)
    v_mfma_f32_32x32x16_bf16 v[120:135], v[112:115], v[84:87], v[120:135]
    s_waitcnt vmcnt(3)
    v_perm_b32 v168, v168, v168, s66
    v_perm_b32 v169, v169, v169, s66
    v_perm_b32 v170, v170, v170, s66
    v_perm_b32 v171, v171, v171, s66
    s_nop 4
    v_pk_add_f32 v[168:169], v[168:169], v[136:137] neg_lo:[0,1] neg_hi:[0,1]
    v_pk_add_f32 v[170:171], v[170:171], v[138:139] neg_lo:[0,1] neg_hi:[0,1]
    v_pk_fma_f32 v[136:137], v[168:169], v[184:185], v[136:137] op_sel_hi:[1,0,1]
    v_pk_fma_f32 v[138:139], v[170:171], v[184:185], v[138:139] op_sel_hi:[1,0,1]
    v_cvt_pk_bf16_f32 v136, v136, v137
    v_cvt_pk_bf16_f32 v137, v138, v139
    ds_write_b64 v242, v[136:137] offset:64
    s_waitcnt vmcnt(2)
    v_perm_b32 v172, v172, v172, s66
    v_perm_b32 v173, v173, v173, s66
    v_perm_b32 v174, v174, v174, s66
    v_perm_b32 v175, v175, v175, s66
    v_pk_add_f32 v[172:173], v[172:173], v[140:141] neg_lo:[0,1] neg_hi:[0,1]
    v_pk_add_f32 v[174:175], v[174:175], v[142:143] neg_lo:[0,1] neg_hi:[0,1]
    v_pk_fma_f32 v[140:141], v[172:173], v[184:185], v[140:141] op_sel_hi:[1,0,1]
    v_pk_fma_f32 v[142:143], v[174:175], v[184:185], v[142:143] op_sel_hi:[1,0,1]
    v_cvt_pk_bf16_f32 v140, v140, v141
    v_cvt_pk_bf16_f32 v141, v142, v143
    ds_write_b64 v242, v[140:141] offset:80
    s_waitcnt vmcnt(1)
    v_perm_b32 v176, v176, v176, s66
    v_perm_b32 v177, v177, v177, s66
    v_perm_b32 v178, v178, v178, s66
    v_perm_b32 v179, v179, v179, s66
    v_pk_add_f32 v[176:177], v[176:177], v[144:145] neg_lo:[0,1] neg_hi:[0,1]
    v_pk_add_f32 v[178:179], v[178:179], v[146:147] neg_lo:[0,1] neg_hi:[0,1]
    v_pk_fma_f32 v[144:145], v[176:177], v[184:185], v[144:145] op_sel_hi:[1,0,1]
    v_pk_fma_f32 v[146:147], v[178:179], v[184:185], v[146:147] op_sel_hi:[1,0,1]
    v_cvt_pk_bf16_f32 v144, v144, v145
    v_cvt_pk_bf16_f32 v145, v146, v147
    ds_write_b64 v242, v[144:145] offset:96
    s_waitcnt vmcnt(0)
    v_perm_b32 v180, v180, v180, s66
    v_perm_b32 v181, v181, v181, s66
    v_perm_b32 v182, v182, v182, s66
    v_perm_b32 v183, v183, v183, s66
    v_pk_add_f32 v[180:181], v[180:181], v[148:149] neg_lo:[0,1] neg_hi:[0,1]
    v_pk_add_f32 v[182:183], v[182:183], v[150:151] neg_lo:[0,1] neg_hi:[0,1]
    v_pk_fma_f32 v[148:149], v[180:181], v[184:185], v[148:149] op_sel_hi:[1,0,1]
    v_pk_fma_f32 v[150:151], v[182:183], v[184:185], v[150:151] op_sel_hi:[1,0,1]
    v_cvt_pk_bf16_f32 v148, v148, v149
    v_cvt_pk_bf16_f32 v149, v150, v151
    ds_write_b64 v242, v[148:149] offset:112
    v_perm_b32 v152, v152, v152, s66
    v_perm_b32 v153, v153, v153, s66
    v_perm_b32 v154, v154, v154, s66
    v_perm_b32 v155, v155, v155, s66
    v_pk_add_f32 v[152:153], v[152:153], v[120:121] neg_lo:[0,1] neg_hi:[0,1]
    v_pk_add_f32 v[154:155], v[154:155], v[122:123] neg_lo:[0,1] neg_hi:[0,1]
    v_pk_fma_f32 v[120:121], v[152:153], v[184:185], v[120:121] op_sel_hi:[1,0,1]
    v_pk_fma_f32 v[122:123], v[154:155], v[184:185], v[122:123] op_sel_hi:[1,0,1]
L_hop22:
    s_cbranch_execz L_hopback
    v_cvt_pk_bf16_f32 v120, v120, v121
    v_cvt_pk_bf16_f32 v121, v122, v123
    ds_write_b64 v242, v[120:121] offset:0
    v_perm_b32 v156, v156, v156, s66
    v_perm_b32 v157, v157, v157, s66
    v_perm_b32 v158, v158, v158, s66
    v_perm_b32 v159, v159, v159, s66
    v_pk_add_f32 v[156:157], v[156:157], v[124:125] neg_lo:[0,1] neg_hi:[0,1]
    v_pk_add_f32 v[158:159], v[158:159], v[126:127] neg_lo:[0,1] neg_hi:[0,1]
    v_pk_fma_f32 v[124:125], v[156:157], v[184:185], v[124:125] op_sel_hi:[1,0,1]
    v_pk_fma_f32 v[126:127], v[158:159], v[184:185], v[126:127] op_sel_hi:[1,0,1]
    v_cvt_pk_bf16_f32 v124, v124, v125
    v_cvt_pk_bf16_f32 v125, v126, v127
    ds_write_b64 v242, v[124:125] offset:16
    v_perm_b32 v160, v160, v160, s66
    v_perm_b32 v161, v161, v161, s66
    v_perm_b32 v162, v162, v162, s66
    v_perm_b32 v163, v163, v163, s66
    v_pk_add_f32 v[160:161], v[160:161], v[128:129] neg_lo:[0,1] neg_hi:[0,1]
    v_pk_add_f32 v[162:163], v[162:163], v[130:131] neg_lo:[0,1] neg_hi:[0,1]
    v_pk_fma_f32 v[128:129], v[160:161], v[184:185], v[128:129] op_sel_hi:[1,0,1]
    v_pk_fma_f32 v[130:131], v[162:163], v[184:185], v[130:131] op_sel_hi:[1,0,1]
    v_cvt_pk_bf16_f32 v128, v128, v129
    v_cvt_pk_bf16_f32 v129, v130, v131
    ds_write_b64 v242, v[128:129] offset:32
    v_perm_b32 v164, v164, v164, s66
    v_perm_b32 v165, v165, v165, s66
    v_perm_b32 v166, v166, v166, s66
    v_perm_b32 v167, v167, v167, s66
    v_pk_add_f32 v[164:165], v[164:165], v[132:133] neg_lo:[0,1] neg_hi:[0,1]
    v_pk_add_f32 v[166:167], v[166:167], v[134:135] neg_lo:[0,1] neg_hi:[0,1]
    v_pk_fma_f32 v[132:133], v[164:165], v[184:185], v[132:133] op_sel_hi:[1,0,1]
    v_pk_fma_f32 v[134:135], v[166:167], v[184:185], v[134:135] op_sel_hi:[1,0,1]
    v_cvt_pk_bf16_f32 v132, v132, v133
    v_cvt_pk_bf16_f32 v133, v134, v135
    ds_write_b64 v242, v[132:133] offset:48
    ds_read_b128 v[24:27], v243 offset:0
    ds_read_b128 v[28:31], v243 offset:1152
    ds_read_b128 v[32:35], v243 offset:2304
    ds_read_b128 v[36:39], v243 offset:3456
    s_waitcnt lgkmcnt(3)
    buffer_store_dwordx4 v[24:27], v241, s[24:27], s67 offen
    s_add_u32 s67, s67, 16384
    s_waitcnt lgkmcnt(2)
    buffer_store_dwordx4 v[28:31], v241, s[24:27], s67 offen
    s_add_u32 s67, s67, 16384
    s_waitcnt lgkmcnt(1)
    buffer_store_dwordx4 v[32:35], v241, s[24:27], s67 offen
    s_add_u32 s67, s67, 16384
    s_waitcnt lgkmcnt(0)
    buffer_store_dwordx4 v[36:39], v241, s[24:27], s67 offen
L_end:
    s_endpgm
.section .rodata,"a"
.p2align 6
.amdhsa_kernel gated_mix__ssm_conv_s4d__linear_attn_block__prompt_kernel
  .amdhsa_next_free_vgpr 256
  .amdhsa_next_free_sgpr 102
  .amdhsa_accum_offset 256
  .amdhsa_group_segment_fixed_size 0
  .amdhsa_kernarg_size 112
  .amdhsa_user_sgpr_count 2
  .amdhsa_user_sgpr_kernarg_segment_ptr 1
  .amdhsa_system_sgpr_workgroup_id_x 1
  .amdhsa_float_denorm_mode_32 3
  .amdhsa_float_denorm_mode_16_64 3
.end_amdhsa_kernel
```
